```python
import torch

def _softmax(x, axis=-1):
    return torch.softmax(x, dim=axis)
def _gelu(x):
    return torch.nn.functional.gelu(x, approximate="tanh")
def _silu(x):
    return torch.nn.functional.silu(x)
def _sigmoid(x):
    return torch.sigmoid(x)
def _layernorm(x, axis=-1, eps=1e-5):
    m = x.mean(dim=axis, keepdim=True)
    v = x.var(dim=axis, keepdim=True, unbiased=False)
    return (x - m) / torch.sqrt(v + eps)
def _scatter_add(tgt, idx, src, axis=0):
    return tgt.clone().index_add_(axis, idx, src)
def _segment_sum(src, seg, n):
    out = torch.zeros((n,) + src.shape[1:], dtype=src.dtype)
    return out.index_add_(0, seg, src)
def _pad(x, pw):
    flat = tuple(v for pair in reversed(pw) for v in pair)
    return torch.nn.functional.pad(x, flat)

kernel_name = 'recurrent_scan__ssm_conv_h3__dense_activation_relu__prompt'

def setup_inputs():

    _w = (lambda a: (lambda t: t.to(torch.bfloat16) if t.is_floating_point() else t)(torch.as_tensor(a)))
    def _A_setup():
        B, S, D = 1, 2048, 512
        ks = 4
        return {
            "q": _w((lambda *s: torch.randn(*s, dtype=torch.bfloat16) * 0.05)(B, S, D)),
            "k": _w((lambda *s: torch.randn(*s, dtype=torch.bfloat16) * 0.2)(B, S, D)),
            "v": _w((lambda *s: torch.randn(*s, dtype=torch.bfloat16) * 0.2)(B, S, D)),
            "shift_k": _w((lambda *s: torch.randn(*s, dtype=torch.bfloat16) * 0.2)(D, ks) * 0.5),
            "ssm_k": _w((lambda *s: torch.randn(*s, dtype=torch.bfloat16) * 0.2)(D, S) * (1.0 / S ** 0.5)),
            "ssm_D": _w((lambda *s: torch.randn(*s, dtype=torch.bfloat16) * 0.2)(D)),
        }
    _A_in = _A_setup()

    def _B_setup():
        B, S, D, Dff = 1, 2048, 512, 1376
        return {
            "x": _w((lambda *s: torch.randn(*s, dtype=torch.bfloat16) * 0.05)(B, S, D)),
            "w1": _w((lambda *s: torch.randn(*s, dtype=torch.bfloat16) * 0.1)(D, Dff)),
            "w2": _w((lambda *s: torch.randn(*s, dtype=torch.bfloat16) * 0.1)(Dff, D)),
        }
    _B_in = _B_setup()

    return {
        "A_q": _A_in["q"],
        "A_k": _A_in["k"],
        "A_v": _A_in["v"],
        "A_shift_k": _A_in["shift_k"],
        "A_ssm_k": _A_in["ssm_k"],
        "A_ssm_D": _A_in["ssm_D"],
        "B_x": _B_in["x"],
        "B_w1": _B_in["w1"],
        "B_w2": _B_in["w2"],
    }

def reference(A_q, A_k, A_v, A_shift_k, A_ssm_k, A_ssm_D, B_x, B_w1, B_w2):
    def _A_ref(q, k, v, shift_k, ssm_k, ssm_D):
        B, S, D = q.shape
        ks = shift_k.shape[-1]
        k_pad = _pad(k, ((0, 0), (ks - 1, 0), (0, 0)))
        k_shift = torch.zeros_like(k)
        for t in range(ks):
            k_shift = k_shift + k_pad[:, t:t + S, :] * shift_k[:, ks - 1 - t][None, None, :]
        kv = k_shift * v
        L = 2 * S
        kv_pad = _pad(kv, ((0, 0), (0, S), (0, 0)))
        kf_pad = _pad(ssm_k, ((0, 0), (0, S)))
        kv_f = (lambda x, axes=(-2,-1): torch.fft.rfft2(x.float(), dim=axes))(kv_pad[:, None, :, :], axes=(1, 2))
        kf_f = (lambda x, axes=(-2,-1): torch.fft.rfft2(x.float(), dim=axes))(kf_pad[:, None, :], axes=(1, 2))
        kf_f = (lambda x, *d: x.permute(*d))(kf_f, 1, 2, 0)
        y_f = kv_f * kf_f[None, :, :, :]
        y = (lambda x, s, axes=(-2,-1): torch.fft.irfft2(x, s=s, dim=axes).to(torch.bfloat16))(y_f, (1, L), axes=(1, 2))[:, 0, :S, :]
        y = y + kv * ssm_D[None, None, :]
        return q * y

    def _B_ref(x, w1, w2):
        h = torch.einsum("bsd,df->bsf", x, w1)
        zero = torch.zeros_like(h)
        h = torch.maximum(h, zero)
        return torch.einsum("bsf,fd->bsd", h, w2)

    x = A_q
    xn = _layernorm(x, axis=-1)
    s = _A_ref(xn, A_k, A_v, A_shift_k, A_ssm_k, A_ssm_D)
    g = _silu(_B_ref(xn, B_w1, B_w2))
    return x + s * g
```

```asm
; @launch grid=(256,1,1) block=(256,1,1) lds=160256
.amdgcn_target "amdgcn-amd-amdhsa--gfx950"
.text
.globl recurrent_scan__ssm_conv_h3__dense_activation_relu__prompt_kernel
.p2align 8
.type recurrent_scan__ssm_conv_h3__dense_activation_relu__prompt_kernel,@function
recurrent_scan__ssm_conv_h3__dense_activation_relu__prompt_kernel:
    s_cmp_ge_u32 s2, 256
    s_cbranch_scc1 L_end
    s_load_dwordx16 s[24:39], s[0:1], 0
    s_load_dwordx8 s[40:47], s[0:1], 64
    s_getpc_b64 s[48:49]
L_pc:
    s_sub_u32 s48, s48, L_pc-recurrent_scan__ssm_conv_h3__dense_activation_relu__prompt_kernel
    s_subb_u32 s49, s49, 0
    v_lshlrev_b32 v2, 7, v0
    v_cmp_gt_u32 vcc, L_end-recurrent_scan__ssm_conv_h3__dense_activation_relu__prompt_kernel+128, v2
    s_nop 0
    s_and_saveexec_b64 s[50:51], vcc
    s_cbranch_execz L_nopf
    global_load_dword v3, v2, s[48:49]
L_nopf:
    s_mov_b64 exec, s[50:51]
    v_lshrrev_b32 v1, 6, v0
    s_and_b32 s4, s2, 7
    s_lshr_b32 s5, s2, 3
    v_readfirstlane_b32 s3, v1
    v_and_b32 v1, 63, v0
    s_and_b32 s6, s5, 1
    s_lshl_b32 s48, s4, 1
    s_add_u32 s6, s6, s48
    s_lshr_b32 s7, s5, 1
    s_lshl_b32 s48, s4, 6
    s_lshl_b32 s49, s5, 1
    s_add_u32 s58, s48, s49
    v_and_b32 v56, 15, v0
    v_lshrrev_b32 v57, 4, v0
    s_lshl_b32 s51, s5, 6
    v_lshlrev_b32 v60, 2, v57
    v_add_u32 v60, s51, v60
    v_lshlrev_b32 v60, 10, v60
    v_lshl_add_u32 v60, v56, 3, v60
    s_lshl_b32 s52, s4, 7
    v_add_u32 v60, s52, v60
    v_add_u32 v61, 4294964224, v60
    v_add_u32 v62, 4294965248, v60
    v_add_u32 v63, 4294966272, v60
    v_add_u32 v65, 1024, v60
    v_add_u32 v66, 2048, v60
    v_add_u32 v67, 3072, v60
    v_lshlrev_b32 v58, 4, v1
    s_lshl_b32 s48, s6, 7
    s_lshl_b32 s49, s7, 3
    s_add_u32 s48, s48, s49
    s_lshl_b32 s49, s3, 1
    s_add_u32 s56, s48, s49
    s_lshl_b32 s50, s56, 10
    v_lshlrev_b32 v68, 5, v56
    s_lshl_b32 s53, s4, 9
    s_waitcnt lgkmcnt(0)
    s_mov_b32 s12, s26
    s_mov_b32 s13, s27
    s_mov_b32 s14, 0x200000
    s_mov_b32 s15, 0x20000
    s_mov_b32 s16, s28
    s_mov_b32 s17, s29
    s_mov_b32 s18, 0x200000
    s_mov_b32 s19, 0x20000
    buffer_load_dwordx2 v[16:17], v61, s[12:15], 0 offen
    buffer_load_dwordx2 v[18:19], v62, s[12:15], 0 offen
    buffer_load_dwordx2 v[20:21], v63, s[12:15], 0 offen
    buffer_load_dwordx2 v[22:23], v60, s[12:15], 0 offen
    buffer_load_dwordx2 v[24:25], v65, s[12:15], 0 offen
    buffer_load_dwordx2 v[26:27], v66, s[12:15], 0 offen
    buffer_load_dwordx2 v[28:29], v67, s[12:15], 0 offen
    s_mov_b32 s20, s30
    s_mov_b32 s21, s31
    s_mov_b32 s22, 0x1000
    s_mov_b32 s23, 0x20000
    buffer_load_dwordx2 v[30:31], v60, s[16:19], 0 offen offset:0
    buffer_load_dwordx2 v[32:33], v60, s[16:19], 0 offen offset:1024
    buffer_load_dwordx2 v[34:35], v60, s[16:19], 0 offen offset:2048
    buffer_load_dwordx2 v[36:37], v60, s[16:19], 0 offen offset:3072
    s_mov_b32 s8, s24
    s_mov_b32 s9, s25
    s_mov_b32 s10, 0x200000
    s_mov_b32 s11, 0x20000
    buffer_load_dwordx4 v[38:41], v68, s[20:23], s53 offen
    buffer_load_dwordx4 v[42:45], v68, s[20:23], s53 offen offset:16
    buffer_load_dwordx4 v[48:51], v58, s[8:11], s50 offen
    buffer_load_dwordx4 v[52:55], v58, s[8:11], s50 offen offset:1024
    v_lshlrev_b32 v70, 21, v1
    s_mov_b64 exec, 0xff
    global_load_dword v254, v70, s[46:47] sc1
    s_mov_b64 exec, 1
    global_load_dword v254, v70, s[42:43]
    global_load_dword v254, v70, s[32:33]
    global_load_dword v254, v70, s[38:39]
    s_mov_b64 exec, -1
    s_lshl_b32 s48, s58, 12
    s_lshl_b32 s49, s3, 11
    s_add_u32 s48, s48, s49
    v_lshlrev_b32 v70, 7, v1
    v_add_u32 v70, s48, v70
    s_mov_b64 exec, 0xffff
    global_load_dword v254, v70, s[32:33]
    s_mov_b64 exec, -1
    s_mul_i32 s59, s7, 3
    s_lshl_b32 s48, s7, 1
    s_add_u32 s48, s48, 11
    s_cmp_lt_u32 s7, 11
    s_cselect_b32 s59, s59, s48
    s_and_b32 s65, s7, 1
    s_lshl_b32 s48, s6, 1
    s_add_u32 s65, s65, s48
    s_lshr_b32 s66, s7, 1
    s_mul_i32 s67, s3, 22
    s_and_b32 s48, s5, 1
    s_lshl_b32 s48, s48, 1
    s_and_b32 s49, s7, 1
    s_add_u32 s48, s48, s49
    s_mul_i32 s48, s48, 5
    s_mul_i32 s49, s66, 3
    s_add_u32 s48, s48, s49
    s_sub_u32 s49, s48, 20
    s_cmp_ge_u32 s48, 20
    s_cselect_b32 s48, s49, s48
    s_and_b32 s57, s48, 30
    s_cmp_eq_u32 s3, 3
    s_cselect_b32 s63, 20, 22
    s_mov_b32 s20, s40
    s_mov_b32 s21, s41
    s_mov_b32 s22, 0x158000
    s_mov_b32 s23, 0x20000
    v_lshrrev_b32 v70, 3, v1
    v_lshlrev_b32 v70, 11, v70
    v_and_b32 v71, 7, v1
    v_lshl_add_u32 v70, v71, 4, v70
    s_lshl_b32 s48, s4, 7
    v_add_u32 v70, s48, v70
    v_xor_b32 v71, 64, v70
    s_lshl_b32 s48, s3, 5
    s_add_u32 s64, s48, s5
    s_lshl_b32 s49, s64, 14
    s_lshl_b32 s48, s3, 11
    s_add_u32 s48, s48, 49152
    s_mov_b32 m0, s48
    s_nop 0
    buffer_load_dwordx4 v70, s[20:23], s49 offen lds
    buffer_load_dwordx4 v71, s[20:23], s49 offen offset:1024 lds
    v_lshlrev_b32 v252, 4, v0
    s_add_u32 s48, s46, 0xc00000
    s_addc_u32 s49, s47, 0
    s_load_dword s61, s[48:49], 0
    s_lshl_b32 s50, s58, 1
    s_add_u32 s52, s34, s50
    s_addc_u32 s53, s35, 0
    s_load_dword s71, s[52:53], 0
    s_lshl_b32 s50, s58, 12
    s_add_u32 s52, s32, s50
    s_addc_u32 s53, s33, 0
    s_load_dwordx2 s[92:93], s[52:53], 0
    s_load_dwordx2 s[94:95], s[52:53], 4096
    s_mov_b32 s16, s24
    s_mov_b32 s17, s25
    s_mov_b32 s18, 0x200000
    s_mov_b32 s19, 0x20000
    s_mov_b32 s20, s38
    s_mov_b32 s21, s39
    s_mov_b32 s22, 0x158000
    s_mov_b32 s23, 0x20000
    v_lshrrev_b32 v72, 3, v1
    v_and_b32 v73, 7, v1
    v_lshrrev_b32 v74, 1, v72
    v_xor_b32 v73, v73, v74
    s_lshl_b32 s48, s6, 7
    s_lshl_b32 s49, s3, 5
    s_add_u32 s48, s48, s49
    v_lshlrev_b32 v72, 2, v72
    v_add_u32 v72, s48, v72
    v_lshlrev_b32 v72, 10, v72
    v_lshl_add_u32 v136, v73, 4, v72
    v_xor_b32 v137, 64, v136
    s_mul_i32 s48, s3, 192
    s_lshl_b32 s49, s59, 6
    s_mov_b32 s54, 43691
    s_cmp_ge_u32 s7, 11
    s_cselect_b32 s55, 8, 99
    v_mov_b32 v75, 0x7f000000
    v_add_u32 v72, s48, v1
    v_mul_lo_u32 v73, v72, s54
    v_lshrrev_b32 v73, 19, v73
    v_mul_u32_u24 v74, 12, v73
    v_sub_u32 v74, v72, v74
    v_mul_u32_u24 v73, 2752, v73
    v_lshl_add_u32 v73, v74, 4, v73
    v_add_u32 v73, s49, v73
    v_mov_b32 v138, v73
    v_cmp_le_u32 vcc, s55, v74
    s_nop 1
    v_cndmask_b32 v138, v138, v75, vcc
    v_add_u32 v72, s48, v1
    v_add_u32 v72, 64, v72
    v_mul_lo_u32 v73, v72, s54
    v_lshrrev_b32 v73, 19, v73
    v_mul_u32_u24 v74, 12, v73
    v_sub_u32 v74, v72, v74
    v_mul_u32_u24 v73, 2752, v73
    v_lshl_add_u32 v73, v74, 4, v73
    v_add_u32 v73, s49, v73
    v_subrev_u32 v139, 1024, v73
    v_cmp_le_u32 vcc, s55, v74
    s_nop 1
    v_cndmask_b32 v139, v139, v75, vcc
    v_add_u32 v72, s48, v1
    v_add_u32 v72, 128, v72
    v_mul_lo_u32 v73, v72, s54
    v_lshrrev_b32 v73, 19, v73
    v_mul_u32_u24 v74, 12, v73
    v_sub_u32 v74, v72, v74
    v_mul_u32_u24 v73, 2752, v73
    v_lshl_add_u32 v73, v74, 4, v73
    v_add_u32 v73, s49, v73
    v_subrev_u32 v140, 2048, v73
    v_cmp_le_u32 vcc, s55, v74
    s_nop 1
    v_cndmask_b32 v140, v140, v75, vcc
    s_mov_b32 s68, 0
    s_mov_b32 s69, 0
    s_mov_b32 s70, 0
    v_sub_u32 v72, 15, v57
    v_lshrrev_b32 v73, 1, v72
    v_and_b32 v74, 7, v56
    v_xor_b32 v73, v73, v74
    v_lshlrev_b32 v73, 4, v73
    v_and_b32 v72, 1, v72
    v_lshl_add_u32 v73, v72, 3, v73
    v_lshl_add_u32 v73, v56, 9, v73
    v_add_u32 v148, 147968, v73
    v_lshrrev_b32 v72, 3, v0
    v_and_b32 v73, 7, v0
    v_bfe_u32 v74, v72, 2, 3
    v_xor_b32 v74, v74, v73
    v_lshlrev_b32 v74, 4, v74
    v_lshl_add_u32 v74, v72, 7, v74
    v_add_u32 v149, 147968, v74
    v_lshlrev_b32 v150, 12, v72
    v_lshl_add_u32 v150, v73, 4, v150
    v_bfe_u32 v72, v1, 2, 1
    v_lshlrev_b32 v73, 10, v72
    v_lshrrev_b32 v74, 5, v1
    v_lshl_add_u32 v73, v74, 8, v73
    v_bfe_u32 v74, v1, 3, 1
    v_lshl_add_u32 v73, v74, 7, v73
    v_bfe_u32 v74, v1, 4, 1
    v_lshlrev_b32 v74, 1, v74
    v_bfe_u32 v75, v1, 1, 1
    v_add_u32 v74, v74, v75
    v_lshl_add_u32 v74, v72, 2, v74
    v_lshl_add_u32 v73, v74, 4, v73
    v_and_b32 v74, 1, v1
    v_lshl_add_u32 v73, v74, 3, v73
    s_lshl_b32 s48, s3, 11
    s_add_u32 s48, s48, 49152
    v_add_u32 v151, s48, v73
    v_xor_b32 v152, 64, v151
    v_and_b32 v72, 31, v1
    v_lshrrev_b32 v73, 5, v1
    v_bfe_u32 v74, v1, 1, 3
    v_xor_b32 v74, v74, v73
    s_lshl_b32 s48, s3, 12
    v_lshlrev_b32 v72, 7, v72
    v_add_u32 v72, s48, v72
    v_bfe_u32 v76, v1, 2, 2
    v_lshl_add_u32 v76, v73, 3, v76
    v_mul_u32_u24 v76, 192, v76
    v_bfe_u32 v77, v1, 4, 1
    v_lshl_add_u32 v76, v77, 5, v76
    v_and_b32 v77, 3, v1
    v_lshl_add_u32 v76, v77, 3, v76
    v_add_u32 v76, 65536, v76
    s_add_u32 s48, s3, 0
    s_and_b32 s48, s48, 3
    s_lshl_b32 s49, s48, 1
    v_xor_b32 v75, s49, v74
    v_lshl_add_u32 v128, v75, 4, v72
    s_mul_i32 s49, s48, 3072
    v_add_u32 v132, s49, v76
    s_add_u32 s48, s3, 1
    s_and_b32 s48, s48, 3
    s_lshl_b32 s49, s48, 1
    v_xor_b32 v75, s49, v74
    v_lshl_add_u32 v129, v75, 4, v72
    s_mul_i32 s49, s48, 3072
    v_add_u32 v133, s49, v76
    s_add_u32 s48, s3, 2
    s_and_b32 s48, s48, 3
    s_lshl_b32 s49, s48, 1
    v_xor_b32 v75, s49, v74
    v_lshl_add_u32 v130, v75, 4, v72
    s_mul_i32 s49, s48, 3072
    v_add_u32 v134, s49, v76
    s_add_u32 s48, s3, 3
    s_and_b32 s48, s48, 3
    s_lshl_b32 s49, s48, 1
    v_xor_b32 v75, s49, v74
    v_lshl_add_u32 v131, v75, 4, v72
    s_mul_i32 s49, s48, 3072
    v_add_u32 v135, s49, v76
    v_mov_b32 v144, 0x3f803f80
    v_mov_b32 v145, 0x3f803f80
    v_mov_b32 v146, 0x3f803f80
    v_mov_b32 v147, 0x3f803f80
    v_lshlrev_b32 v143, 4, v1
    v_lshlrev_b32 v156, 4, v0
    s_lshr_b32 s48, s3, 1
    s_and_b32 s49, s3, 1
    v_and_b32 v72, 15, v1
    v_lshrrev_b32 v73, 4, v1
    v_add_u32 v74, 1, v72
    v_and_b32 v75, 3, v74
    v_mul_u32_u24 v75, 4160, v75
    v_lshrrev_b32 v74, 2, v74
    v_lshl_add_u32 v75, v74, 3, v75
    v_lshl_add_u32 v75, v73, 4, v75
    s_mul_i32 s50, s48, 16640
    s_lshl_b32 s51, s49, 8
    s_add_u32 s50, s50, s51
    s_add_u32 s50, s50, 114688
    v_add_u32 v8, s50, v75
    s_mul_i32 s50, s48, 4608
    s_add_u32 s50, s50, s51
    s_add_u32 s50, s50, 148448
    v_lshlrev_b32 v74, 5, v72
    v_sub_u32 v74, s50, v74
    v_lshl_add_u32 v9, v73, 4, v74
    v_lshrrev_b32 v72, 4, v0
    v_and_b32 v73, 15, v0
    v_lshlrev_b32 v4, 13, v72
    v_lshl_add_u32 v4, v73, 4, v4
    v_mul_u32_u24 v5, 272, v72
    v_lshl_add_u32 v5, v73, 4, v5
    v_add_u32 v5, 69632, v5
    v_lshrrev_b32 v72, 3, v0
    v_and_b32 v73, 7, v72
    v_lshlrev_b32 v73, 2, v73
    v_lshrrev_b32 v74, 3, v72
    v_add_u32 v73, v73, v74
    v_and_b32 v74, 7, v0
    v_lshlrev_b32 v7, 10, v73
    v_lshl_add_u32 v7, v74, 4, v7
    v_lshlrev_b32 v6, 3, v73
    v_mul_u32_u24 v10, 272, v72
    v_lshl_add_u32 v10, v74, 5, v10
    v_mul_u32_u24 v11, 1088, v74
    v_lshl_add_u32 v11, v73, 2, v11
    v_add_u32 v11, 69632, v11
    v_and_b32 v72, 31, v1
    v_mul_u32_u24 v72, 272, v72
    v_lshrrev_b32 v73, 5, v1
    v_lshl_add_u32 v72, v73, 4, v72
    s_mul_i32 s48, s3, 17408
    v_add_u32 v12, s48, v72
    s_lshl_b32 s48, s3, 12
    s_add_u32 s48, s48, 0
    s_mov_b32 m0, s48
    s_add_u32 s49, s4, 0
    s_and_b32 s49, s49, 7
    s_lshl_b32 s49, s49, 7
    buffer_load_dwordx4 v136, s[16:19], s49 offen offset:0 lds
    buffer_load_dwordx4 v137, s[16:19], s49 offen offset:1024 lds
    buffer_load_dwordx4 v136, s[16:19], s49 offen offset:2048 lds
    buffer_load_dwordx4 v137, s[16:19], s49 offen offset:3072 lds
    s_mul_i32 s50, s3, 3072
    s_add_u32 s50, s50, 65536
    s_mov_b32 m0, s50
    s_add_u32 s49, s4, 0
    s_and_b32 s49, s49, 7
    s_mul_i32 s49, s49, 176128
    buffer_load_dwordx4 v138, s[20:23], s49 offen offset:0 lds
    buffer_load_dwordx4 v139, s[20:23], s49 offen offset:1024 lds
    buffer_load_dwordx4 v140, s[20:23], s49 offen offset:2048 lds
    s_waitcnt vmcnt(14)
    v_lshlrev_b32 v160, 16, v16
    v_lshlrev_b32 v84, 16, v48
    v_and_b32 v161, 0xffff0000, v16
    v_and_b32 v85, 0xffff0000, v48
    v_lshlrev_b32 v162, 16, v17
    v_lshlrev_b32 v86, 16, v49
    v_and_b32 v163, 0xffff0000, v17
    v_and_b32 v87, 0xffff0000, v49
    v_lshlrev_b32 v164, 16, v18
    v_lshlrev_b32 v88, 16, v50
    v_and_b32 v165, 0xffff0000, v18
    v_and_b32 v89, 0xffff0000, v50
    v_lshlrev_b32 v166, 16, v19
    v_lshlrev_b32 v90, 16, v51
    v_and_b32 v167, 0xffff0000, v19
    v_and_b32 v91, 0xffff0000, v51
    v_lshlrev_b32 v168, 16, v20
    v_lshlrev_b32 v92, 16, v52
    v_and_b32 v169, 0xffff0000, v20
    v_and_b32 v93, 0xffff0000, v52
    v_lshlrev_b32 v170, 16, v21
    v_lshlrev_b32 v94, 16, v53
    v_and_b32 v171, 0xffff0000, v21
    v_and_b32 v95, 0xffff0000, v53
    v_lshlrev_b32 v172, 16, v22
    v_lshlrev_b32 v96, 16, v54
    v_and_b32 v173, 0xffff0000, v22
    v_and_b32 v97, 0xffff0000, v54
    v_lshlrev_b32 v174, 16, v23
    v_lshlrev_b32 v98, 16, v55
    v_and_b32 v175, 0xffff0000, v23
    v_and_b32 v99, 0xffff0000, v55
    v_lshlrev_b32 v176, 16, v24
    v_pk_add_f32 v[100:101], v[84:85], v[86:87]
    v_and_b32 v177, 0xffff0000, v24
    v_pk_add_f32 v[102:103], v[92:93], v[94:95]
    v_lshlrev_b32 v178, 16, v25
    v_pk_add_f32 v[100:101], v[100:101], v[88:89]
    v_and_b32 v179, 0xffff0000, v25
    v_pk_add_f32 v[102:103], v[102:103], v[96:97]
    v_lshlrev_b32 v180, 16, v26
    v_pk_add_f32 v[100:101], v[100:101], v[90:91]
    v_and_b32 v181, 0xffff0000, v26
    v_pk_add_f32 v[102:103], v[102:103], v[98:99]
    v_lshlrev_b32 v182, 16, v27
    v_add_f32 v100, v100, v101
    v_and_b32 v183, 0xffff0000, v27
    v_add_f32 v102, v102, v103
    v_lshlrev_b32 v184, 16, v28
    v_add_f32_dpp v100, v100, v100 row_shr:1 row_mask:0xf bank_mask:0xf bound_ctrl:0
    v_and_b32 v185, 0xffff0000, v28
    v_add_f32_dpp v102, v102, v102 row_shr:1 row_mask:0xf bank_mask:0xf bound_ctrl:0
    v_lshlrev_b32 v186, 16, v29
    v_add_f32_dpp v100, v100, v100 row_shr:2 row_mask:0xf bank_mask:0xf bound_ctrl:0
    v_and_b32 v187, 0xffff0000, v29
    v_lshlrev_b32 v204, 16, v38
    v_add_f32_dpp v102, v102, v102 row_shr:2 row_mask:0xf bank_mask:0xf bound_ctrl:0
    v_and_b32 v208, 0xffff0000, v38
    v_add_f32_dpp v100, v100, v100 row_shr:4 row_mask:0xf bank_mask:0xf bound_ctrl:0
    v_lshlrev_b32 v212, 16, v39
    v_add_f32_dpp v102, v102, v102 row_shr:4 row_mask:0xf bank_mask:0xf bound_ctrl:0
    v_and_b32 v216, 0xffff0000, v39
    v_add_f32_dpp v100, v100, v100 row_shr:8 row_mask:0xf bank_mask:0xf bound_ctrl:0
    v_lshlrev_b32 v205, 16, v40
    v_add_f32_dpp v102, v102, v102 row_shr:8 row_mask:0xf bank_mask:0xf bound_ctrl:0
    v_and_b32 v209, 0xffff0000, v40
    v_add_f32_dpp v100, v100, v100 row_bcast:15 row_mask:0xa bank_mask:0xf
    v_lshlrev_b32 v213, 16, v41
    v_add_f32_dpp v102, v102, v102 row_bcast:15 row_mask:0xa bank_mask:0xf
    v_and_b32 v217, 0xffff0000, v41
    v_add_f32_dpp v100, v100, v100 row_bcast:31 row_mask:0xc bank_mask:0xf
    v_lshlrev_b32 v206, 16, v42
    v_add_f32_dpp v102, v102, v102 row_bcast:31 row_mask:0xc bank_mask:0xf
    v_and_b32 v210, 0xffff0000, v42
    v_readlane_b32 s54, v100, 63
    v_lshlrev_b32 v214, 16, v43
    v_readlane_b32 s55, v102, 63
    v_and_b32 v218, 0xffff0000, v43
    s_mov_b32 s52, 0x3b000000
    v_lshlrev_b32 v207, 16, v44
    v_mov_b32 v104, s54
    v_and_b32 v211, 0xffff0000, v44
    v_mov_b32 v106, s55
    v_lshlrev_b32 v215, 16, v45
    v_mul_f32 v104, s52, v104
    v_and_b32 v219, 0xffff0000, v45
    v_mul_f32 v106, s52, v106
    v_lshlrev_b32 v188, 16, v30
    v_mov_b32 v105, v104
    v_and_b32 v189, 0xffff0000, v30
    v_mov_b32 v107, v106
    v_lshlrev_b32 v190, 16, v31
    v_pk_add_f32 v[84:85], v[84:85], v[104:105] neg_lo:[0,1] neg_hi:[0,1]
    v_and_b32 v191, 0xffff0000, v31
    v_pk_add_f32 v[92:93], v[92:93], v[106:107] neg_lo:[0,1] neg_hi:[0,1]
    v_lshlrev_b32 v192, 16, v32
    v_pk_add_f32 v[86:87], v[86:87], v[104:105] neg_lo:[0,1] neg_hi:[0,1]
    v_and_b32 v193, 0xffff0000, v32
    v_pk_add_f32 v[94:95], v[94:95], v[106:107] neg_lo:[0,1] neg_hi:[0,1]
    v_lshlrev_b32 v194, 16, v33
    v_pk_add_f32 v[88:89], v[88:89], v[104:105] neg_lo:[0,1] neg_hi:[0,1]
    v_and_b32 v195, 0xffff0000, v33
    v_pk_add_f32 v[96:97], v[96:97], v[106:107] neg_lo:[0,1] neg_hi:[0,1]
    v_lshlrev_b32 v196, 16, v34
    v_pk_add_f32 v[90:91], v[90:91], v[104:105] neg_lo:[0,1] neg_hi:[0,1]
    v_and_b32 v197, 0xffff0000, v34
    v_pk_add_f32 v[98:99], v[98:99], v[106:107] neg_lo:[0,1] neg_hi:[0,1]
    v_lshlrev_b32 v198, 16, v35
    v_pk_mul_f32 v[100:101], v[84:85], v[84:85]
    v_and_b32 v199, 0xffff0000, v35
    v_lshlrev_b32 v200, 16, v36
    v_pk_mul_f32 v[102:103], v[92:93], v[92:93]
    v_and_b32 v201, 0xffff0000, v36
    v_pk_fma_f32 v[100:101], v[86:87], v[86:87], v[100:101]
    v_lshlrev_b32 v202, 16, v37
    v_pk_fma_f32 v[102:103], v[94:95], v[94:95], v[102:103]
    v_and_b32 v203, 0xffff0000, v37
    v_pk_fma_f32 v[100:101], v[88:89], v[88:89], v[100:101]
    v_pk_mul_f32 v[220:221], v[160:161], v[216:217]
    v_pk_fma_f32 v[102:103], v[96:97], v[96:97], v[102:103]
    v_pk_mul_f32 v[222:223], v[162:163], v[218:219]
    v_pk_fma_f32 v[100:101], v[90:91], v[90:91], v[100:101]
    v_pk_mul_f32 v[224:225], v[164:165], v[216:217]
    v_pk_fma_f32 v[102:103], v[98:99], v[98:99], v[102:103]
    v_pk_mul_f32 v[226:227], v[166:167], v[218:219]
    v_add_f32 v100, v100, v101
    v_pk_mul_f32 v[228:229], v[168:169], v[216:217]
    v_add_f32 v102, v102, v103
    v_pk_mul_f32 v[230:231], v[170:171], v[218:219]
    v_add_f32_dpp v100, v100, v100 row_shr:1 row_mask:0xf bank_mask:0xf bound_ctrl:0
    v_pk_mul_f32 v[232:233], v[172:173], v[216:217]
    v_add_f32_dpp v102, v102, v102 row_shr:1 row_mask:0xf bank_mask:0xf bound_ctrl:0
    v_pk_mul_f32 v[234:235], v[174:175], v[218:219]
    v_add_f32_dpp v100, v100, v100 row_shr:2 row_mask:0xf bank_mask:0xf bound_ctrl:0
    v_pk_fma_f32 v[220:221], v[164:165], v[212:213], v[220:221]
    v_add_f32_dpp v102, v102, v102 row_shr:2 row_mask:0xf bank_mask:0xf bound_ctrl:0
    v_pk_fma_f32 v[222:223], v[166:167], v[214:215], v[222:223]
    v_add_f32_dpp v100, v100, v100 row_shr:4 row_mask:0xf bank_mask:0xf bound_ctrl:0
    v_pk_fma_f32 v[224:225], v[168:169], v[212:213], v[224:225]
    v_add_f32_dpp v102, v102, v102 row_shr:4 row_mask:0xf bank_mask:0xf bound_ctrl:0
    v_pk_fma_f32 v[226:227], v[170:171], v[214:215], v[226:227]
    v_add_f32_dpp v100, v100, v100 row_shr:8 row_mask:0xf bank_mask:0xf bound_ctrl:0
    v_pk_fma_f32 v[228:229], v[172:173], v[212:213], v[228:229]
    v_add_f32_dpp v102, v102, v102 row_shr:8 row_mask:0xf bank_mask:0xf bound_ctrl:0
    v_pk_fma_f32 v[230:231], v[174:175], v[214:215], v[230:231]
    v_add_f32_dpp v100, v100, v100 row_bcast:15 row_mask:0xa bank_mask:0xf
    v_pk_fma_f32 v[232:233], v[176:177], v[212:213], v[232:233]
    v_add_f32_dpp v102, v102, v102 row_bcast:15 row_mask:0xa bank_mask:0xf
    v_pk_fma_f32 v[234:235], v[178:179], v[214:215], v[234:235]
    v_add_f32_dpp v100, v100, v100 row_bcast:31 row_mask:0xc bank_mask:0xf
    v_pk_fma_f32 v[220:221], v[168:169], v[208:209], v[220:221]
    v_add_f32_dpp v102, v102, v102 row_bcast:31 row_mask:0xc bank_mask:0xf
    v_pk_fma_f32 v[222:223], v[170:171], v[210:211], v[222:223]
    v_readlane_b32 s54, v100, 63
    v_pk_fma_f32 v[224:225], v[172:173], v[208:209], v[224:225]
    v_readlane_b32 s55, v102, 63
    v_pk_fma_f32 v[226:227], v[174:175], v[210:211], v[226:227]
    v_mov_b32 v100, s54
    v_pk_fma_f32 v[228:229], v[176:177], v[208:209], v[228:229]
    v_mov_b32 v102, s55
    v_pk_fma_f32 v[230:231], v[178:179], v[210:211], v[230:231]
    s_mov_b32 s53, 0x3727c5ac
    v_pk_fma_f32 v[232:233], v[180:181], v[208:209], v[232:233]
    v_mul_f32 v100, s52, v100
    v_pk_fma_f32 v[234:235], v[182:183], v[210:211], v[234:235]
    v_pk_fma_f32 v[220:221], v[172:173], v[204:205], v[220:221]
    v_mul_f32 v102, s52, v102
    v_pk_fma_f32 v[222:223], v[174:175], v[206:207], v[222:223]
    v_cvt_pk_bf16_f32 v100, v100, v100
    v_pk_fma_f32 v[224:225], v[176:177], v[204:205], v[224:225]
    v_and_b32 v100, 0xffff0000, v100
    v_pk_fma_f32 v[226:227], v[178:179], v[206:207], v[226:227]
    v_cvt_pk_bf16_f32 v102, v102, v102
    v_pk_fma_f32 v[228:229], v[180:181], v[204:205], v[228:229]
    v_and_b32 v102, 0xffff0000, v102
    v_pk_fma_f32 v[230:231], v[182:183], v[206:207], v[230:231]
    v_add_f32 v100, s53, v100
    v_pk_fma_f32 v[232:233], v[184:185], v[204:205], v[232:233]
    v_add_f32 v102, s53, v102
    v_pk_fma_f32 v[234:235], v[186:187], v[206:207], v[234:235]
    v_cvt_pk_bf16_f32 v100, v100, v100
    v_pk_mul_f32 v[220:221], v[220:221], v[188:189]
    v_and_b32 v100, 0xffff0000, v100
    v_pk_mul_f32 v[222:223], v[222:223], v[190:191]
    v_cvt_pk_bf16_f32 v102, v102, v102
    v_pk_mul_f32 v[224:225], v[224:225], v[192:193]
    v_and_b32 v102, 0xffff0000, v102
    v_pk_mul_f32 v[226:227], v[226:227], v[194:195]
    v_sqrt_f32 v100, v100
    v_pk_mul_f32 v[228:229], v[228:229], v[196:197]
    v_sqrt_f32 v102, v102
    v_pk_mul_f32 v[230:231], v[230:231], v[198:199]
    v_cvt_pk_bf16_f32 v104, v104, v104
    v_pk_mul_f32 v[232:233], v[232:233], v[200:201]
    v_and_b32 v104, 0xffff0000, v104
    v_pk_mul_f32 v[234:235], v[234:235], v[202:203]
    v_cvt_pk_bf16_f32 v106, v106, v106
    v_cvt_pk_bf16_f32 v64, v232, v228
    v_and_b32 v106, 0xffff0000, v106
    v_cvt_pk_bf16_f32 v65, v224, v220
    v_cvt_pk_bf16_f32 v100, v100, v100
    v_cvt_pk_bf16_f32 v66, v233, v229
    v_and_b32 v100, 0xffff0000, v100
    v_cvt_pk_bf16_f32 v67, v225, v221
    v_cvt_pk_bf16_f32 v102, v102, v102
    v_cvt_pk_bf16_f32 v68, v234, v230
    v_and_b32 v102, 0xffff0000, v102
    v_cvt_pk_bf16_f32 v69, v226, v222
    v_rcp_f32 v100, v100
    v_cvt_pk_bf16_f32 v70, v235, v231
    v_rcp_f32 v102, v102
    v_cvt_pk_bf16_f32 v71, v227, v223
    v_mov_b32 v108, v104
    ds_write_b64 v148, v[64:65] offset:0
    v_mov_b32 v110, v106
    ds_write_b64 v148, v[66:67] offset:128
    v_mov_b32 v109, v100
    ds_write_b64 v148, v[68:69] offset:256
    v_mov_b32 v111, v102
    ds_write_b64 v148, v[70:71] offset:384
    s_waitcnt vmcnt(7)
    ds_read_b64_tr_b16 v[112:113], v151 offset:0
    ds_read_b64_tr_b16 v[114:115], v151 offset:512
    ds_read_b64_tr_b16 v[116:117], v152 offset:0
    ds_read_b64_tr_b16 v[118:119], v152 offset:512
    s_mov_b32 s8, s46
    s_mov_b32 s9, s47
    s_mov_b32 s10, 0x4000
    s_mov_b32 s11, 0x20000
    s_lshl_b32 s53, s56, 3
    v_mov_b32 v173, 0
    s_mul_i32 s48, s4, 176128
    s_add_u32 s48, s48, 0xe00000
    s_add_u32 s12, s46, s48
    s_addc_u32 s13, s47, 0
    s_mov_b32 s14, 0x2b000
    s_mov_b32 s15, 0x20000
    s_lshl_b32 s51, s64, 11
    s_waitcnt lgkmcnt(0)
    s_barrier
    ds_read_b128 v[164:167], v149
    ds_read_b128 v[168:171], v149 offset:4096
    s_lshl_b32 s48, s3, 12
    s_add_u32 s48, s48, 16384
    s_mov_b32 m0, s48
    s_add_u32 s49, s4, 1
    s_and_b32 s49, s49, 7
    s_lshl_b32 s49, s49, 7
    buffer_load_dwordx4 v136, s[16:19], s49 offen offset:0 lds
    buffer_load_dwordx4 v137, s[16:19], s49 offen offset:1024 lds
    buffer_load_dwordx4 v136, s[16:19], s49 offen offset:2048 lds
    buffer_load_dwordx4 v137, s[16:19], s49 offen offset:3072 lds
    s_mul_i32 s50, s3, 3072
    s_add_u32 s50, s50, 77824
    s_mov_b32 m0, s50
    s_add_u32 s49, s4, 1
    s_and_b32 s49, s49, 7
    s_mul_i32 s49, s49, 176128
    buffer_load_dwordx4 v138, s[20:23], s49 offen offset:0 lds
    buffer_load_dwordx4 v139, s[20:23], s49 offen offset:1024 lds
    buffer_load_dwordx4 v140, s[20:23], s49 offen offset:2048 lds
    s_lshl_b32 s48, s3, 12
    s_add_u32 s48, s48, 32768
    s_mov_b32 m0, s48
    s_add_u32 s49, s4, 2
    s_and_b32 s49, s49, 7
    s_lshl_b32 s49, s49, 7
    buffer_load_dwordx4 v136, s[16:19], s49 offen offset:0 lds
    buffer_load_dwordx4 v137, s[16:19], s49 offen offset:1024 lds
    buffer_load_dwordx4 v136, s[16:19], s49 offen offset:2048 lds
    buffer_load_dwordx4 v137, s[16:19], s49 offen offset:3072 lds
    s_mul_i32 s50, s3, 3072
    s_add_u32 s50, s50, 90112
    s_mov_b32 m0, s50
    s_add_u32 s49, s4, 2
    s_and_b32 s49, s49, 7
    s_mul_i32 s49, s49, 176128
    buffer_load_dwordx4 v138, s[20:23], s49 offen offset:0 lds
    buffer_load_dwordx4 v139, s[20:23], s49 offen offset:1024 lds
    buffer_load_dwordx4 v140, s[20:23], s49 offen offset:2048 lds
    s_mov_b64 exec, 1
    buffer_store_dwordx4 v[108:111], v173, s[8:11], s53 offen sc0 sc1
    s_mov_b64 exec, -1
    buffer_store_dwordx4 v[112:115], v143, s[12:15], s51 offen sc0 sc1
    buffer_store_dwordx4 v[116:119], v143, s[12:15], s51 offen offset:1024 sc0 sc1
    s_add_u32 s8, s46, 0x200000
    s_addc_u32 s9, s47, 0
    s_mov_b32 s10, 0x200000
    s_mov_b32 s11, 0x20000
    s_lshl_b32 s54, s4, 18
    s_lshl_b32 s55, s5, 7
    s_sub_u32 s55, 3968, s55
    s_add_u32 s54, s54, s55
    s_add_u32 s55, s54, 0x20000
    s_waitcnt lgkmcnt(0)
    buffer_store_dwordx4 v[164:167], v150, s[8:11], s54 offen sc0 sc1
    buffer_store_dwordx4 v[168:171], v150, s[8:11], s55 offen sc0 sc1
    s_mul_i32 s60, s61, 0x9E3779B1
    s_add_u32 s60, s60, 0x7F4A7C15
    s_waitcnt vmcnt(19) lgkmcnt(0)
    s_barrier
    ds_read_b128 v[76:79], v128
    ds_read_b64_tr_b16 v[64:65], v132 offset:0
    ds_read_b64_tr_b16 v[66:67], v132 offset:768
    ds_read_b64_tr_b16 v[68:69], v132 offset:64
    ds_read_b64_tr_b16 v[70:71], v132 offset:832
    ds_read_b64_tr_b16 v[72:73], v132 offset:128
    ds_read_b64_tr_b16 v[74:75], v132 offset:896
    ds_read_b128 v[92:95], v129
    ds_read_b64_tr_b16 v[80:81], v133 offset:0
    ds_read_b64_tr_b16 v[82:83], v133 offset:768
    ds_read_b64_tr_b16 v[84:85], v133 offset:64
    ds_read_b64_tr_b16 v[86:87], v133 offset:832
    ds_read_b64_tr_b16 v[88:89], v133 offset:128
    ds_read_b64_tr_b16 v[90:91], v133 offset:896
    s_waitcnt lgkmcnt(0)
    v_mfma_f32_32x32x16_bf16 v[16:31], v[64:67], v[76:79], 0
    ds_read_b128 v[108:111], v130
    ds_read_b64_tr_b16 v[96:97], v134 offset:0
    ds_read_b64_tr_b16 v[98:99], v134 offset:768
    ds_read_b64_tr_b16 v[100:101], v134 offset:64
    s_lshl_b32 s48, s3, 12
    v_mfma_f32_32x32x16_bf16 v[32:47], v[68:71], v[76:79], 0
    ds_read_b64_tr_b16 v[102:103], v134 offset:832
    ds_read_b64_tr_b16 v[104:105], v134 offset:128
    ds_read_b64_tr_b16 v[106:107], v134 offset:896
    ds_read_b128 v[124:127], v131
    s_add_u32 s48, s48, 49152
    v_mfma_f32_32x32x16_bf16 v[48:63], v[72:75], v[76:79], 0
    ds_read_b64_tr_b16 v[112:113], v135 offset:0
    ds_read_b64_tr_b16 v[114:115], v135 offset:768
    ds_read_b64_tr_b16 v[116:117], v135 offset:64
    ds_read_b64_tr_b16 v[118:119], v135 offset:832
    s_mov_b32 m0, s48
    s_add_u32 s49, s4, 3
    s_and_b32 s49, s49, 7
    s_lshl_b32 s49, s49, 7
    v_mfma_f32_32x32x16_bf16 v[16:31], v[80:83], v[92:95], v[16:31]
    ds_read_b64_tr_b16 v[120:121], v135 offset:128
    ds_read_b64_tr_b16 v[122:123], v135 offset:896
    buffer_load_dwordx4 v136, s[16:19], s49 offen offset:0 lds
    v_mfma_f32_32x32x16_bf16 v[32:47], v[84:87], v[92:95], v[32:47]
    buffer_load_dwordx4 v137, s[16:19], s49 offen offset:1024 lds
    v_mfma_f32_32x32x16_bf16 v[48:63], v[88:91], v[92:95], v[48:63]
    buffer_load_dwordx4 v136, s[16:19], s49 offen offset:2048 lds
    buffer_load_dwordx4 v137, s[16:19], s49 offen offset:3072 lds
    s_waitcnt vmcnt(16) lgkmcnt(0)
    s_barrier
    v_add_u32 v128, 16384, v128
    v_add_u32 v132, 12288, v132
    v_add_u32 v129, 16384, v129
    v_add_u32 v133, 12288, v133
    v_mfma_f32_32x32x16_bf16 v[16:31], v[96:99], v[108:111], v[16:31]
    ds_read_b128 v[76:79], v128
    ds_read_b64_tr_b16 v[64:65], v132 offset:0
    ds_read_b64_tr_b16 v[66:67], v132 offset:768
    ds_read_b64_tr_b16 v[68:69], v132 offset:64
    ds_read_b64_tr_b16 v[70:71], v132 offset:832
    v_mfma_f32_32x32x16_bf16 v[32:47], v[100:103], v[108:111], v[32:47]
    ds_read_b64_tr_b16 v[72:73], v132 offset:128
    ds_read_b64_tr_b16 v[74:75], v132 offset:896
    ds_read_b128 v[92:95], v129
    ds_read_b64_tr_b16 v[80:81], v133 offset:0
    ds_read_b64_tr_b16 v[82:83], v133 offset:768
    s_mul_i32 s50, s3, 3072
    v_mfma_f32_32x32x16_bf16 v[48:63], v[104:107], v[108:111], v[48:63]
    ds_read_b64_tr_b16 v[84:85], v133 offset:64
    ds_read_b64_tr_b16 v[86:87], v133 offset:832
    ds_read_b64_tr_b16 v[88:89], v133 offset:128
    ds_read_b64_tr_b16 v[90:91], v133 offset:896
    v_add_u32 v130, 16384, v130
    s_add_u32 s50, s50, 102400
    v_mfma_f32_32x32x16_bf16 a[176:191], v[144:147], v[96:99], 0
    v_add_u32 v134, 12288, v134
    v_add_u32 v131, 16384, v131
    v_add_u32 v135, 12288, v135
    s_mov_b32 m0, s50
    v_mfma_f32_32x32x16_bf16 a[192:207], v[144:147], v[100:103], 0
    v_mfma_f32_32x32x16_bf16 a[208:223], v[144:147], v[104:107], 0
    s_add_u32 s49, s4, 3
    s_and_b32 s49, s49, 7
    s_mul_i32 s49, s49, 176128
    v_mfma_f32_32x32x16_bf16 v[16:31], v[112:115], v[124:127], v[16:31]
    buffer_load_dwordx4 v138, s[20:23], s49 offen offset:0 lds
    v_mfma_f32_32x32x16_bf16 v[32:47], v[116:119], v[124:127], v[32:47]
    buffer_load_dwordx4 v139, s[20:23], s49 offen offset:1024 lds
    v_mfma_f32_32x32x16_bf16 v[48:63], v[120:123], v[124:127], v[48:63]
    buffer_load_dwordx4 v140, s[20:23], s49 offen offset:2048 lds
    s_waitcnt lgkmcnt(0)
    v_mfma_f32_32x32x16_bf16 v[16:31], v[64:67], v[76:79], v[16:31]
    ds_read_b128 v[108:111], v130
    ds_read_b64_tr_b16 v[96:97], v134 offset:0
    ds_read_b64_tr_b16 v[98:99], v134 offset:768
    ds_read_b64_tr_b16 v[100:101], v134 offset:64
    s_lshl_b32 s48, s3, 12
    v_mfma_f32_32x32x16_bf16 v[32:47], v[68:71], v[76:79], v[32:47]
    ds_read_b64_tr_b16 v[102:103], v134 offset:832
    ds_read_b64_tr_b16 v[104:105], v134 offset:128
    ds_read_b64_tr_b16 v[106:107], v134 offset:896
    ds_read_b128 v[124:127], v131
    s_add_u32 s48, s48, 0
    v_mfma_f32_32x32x16_bf16 v[48:63], v[72:75], v[76:79], v[48:63]
    ds_read_b64_tr_b16 v[112:113], v135 offset:0
    ds_read_b64_tr_b16 v[114:115], v135 offset:768
    ds_read_b64_tr_b16 v[116:117], v135 offset:64
    ds_read_b64_tr_b16 v[118:119], v135 offset:832
    s_mov_b32 m0, s48
    s_add_u32 s49, s4, 4
    s_and_b32 s49, s49, 7
    s_lshl_b32 s49, s49, 7
    v_mfma_f32_32x32x16_bf16 v[16:31], v[80:83], v[92:95], v[16:31]
    ds_read_b64_tr_b16 v[120:121], v135 offset:128
    ds_read_b64_tr_b16 v[122:123], v135 offset:896
    buffer_load_dwordx4 v136, s[16:19], s49 offen offset:0 lds
    v_mfma_f32_32x32x16_bf16 v[32:47], v[84:87], v[92:95], v[32:47]
    buffer_load_dwordx4 v137, s[16:19], s49 offen offset:1024 lds
    v_mfma_f32_32x32x16_bf16 v[48:63], v[88:91], v[92:95], v[48:63]
    buffer_load_dwordx4 v136, s[16:19], s49 offen offset:2048 lds
    buffer_load_dwordx4 v137, s[16:19], s49 offen offset:3072 lds
    s_waitcnt vmcnt(11) lgkmcnt(0)
    s_barrier
    s_cmp_lg_u32 s3, 0
    s_cbranch_scc1 L_pub_1
    s_lshl_b32 s48, s4, 5
    s_add_u32 s48, s48, s5
    s_lshl_b32 s48, s48, 7
    s_add_u32 s48, s48, 0xc01000
    v_mov_b32 v2, s48
    v_mov_b32 v3, s60
    s_mov_b64 exec, 1
    global_store_dword v2, v3, s[46:47] sc0 sc1
    s_mov_b64 exec, -1
L_pub_1:
    v_add_u32 v128, 16384, v128
    v_add_u32 v132, 12288, v132
    v_add_u32 v129, 16384, v129
    v_add_u32 v133, 12288, v133
    v_mfma_f32_32x32x16_bf16 v[16:31], v[96:99], v[108:111], v[16:31]
    ds_read_b128 v[76:79], v128
    ds_read_b64_tr_b16 v[64:65], v132 offset:0
    ds_read_b64_tr_b16 v[66:67], v132 offset:768
    ds_read_b64_tr_b16 v[68:69], v132 offset:64
    ds_read_b64_tr_b16 v[70:71], v132 offset:832
    v_mfma_f32_32x32x16_bf16 v[32:47], v[100:103], v[108:111], v[32:47]
    ds_read_b64_tr_b16 v[72:73], v132 offset:128
    ds_read_b64_tr_b16 v[74:75], v132 offset:896
    ds_read_b128 v[92:95], v129
    ds_read_b64_tr_b16 v[80:81], v133 offset:0
    ds_read_b64_tr_b16 v[82:83], v133 offset:768
    s_mul_i32 s50, s3, 3072
    v_mfma_f32_32x32x16_bf16 v[48:63], v[104:107], v[108:111], v[48:63]
    ds_read_b64_tr_b16 v[84:85], v133 offset:64
    ds_read_b64_tr_b16 v[86:87], v133 offset:832
    ds_read_b64_tr_b16 v[88:89], v133 offset:128
    ds_read_b64_tr_b16 v[90:91], v133 offset:896
    v_add_u32 v130, 16384, v130
    s_add_u32 s50, s50, 65536
    v_mfma_f32_32x32x16_bf16 a[176:191], v[144:147], v[96:99], a[176:191]
    v_add_u32 v134, 12288, v134
    v_add_u32 v131, 16384, v131
    v_add_u32 v135, 12288, v135
    s_mov_b32 m0, s50
    v_mfma_f32_32x32x16_bf16 a[192:207], v[144:147], v[100:103], a[192:207]
    v_mfma_f32_32x32x16_bf16 a[208:223], v[144:147], v[104:107], a[208:223]
    s_add_u32 s49, s4, 4
    s_and_b32 s49, s49, 7
    s_mul_i32 s49, s49, 176128
    v_mfma_f32_32x32x16_bf16 v[16:31], v[112:115], v[124:127], v[16:31]
    buffer_load_dwordx4 v138, s[20:23], s49 offen offset:0 lds
    v_mfma_f32_32x32x16_bf16 v[32:47], v[116:119], v[124:127], v[32:47]
    buffer_load_dwordx4 v139, s[20:23], s49 offen offset:1024 lds
    v_mfma_f32_32x32x16_bf16 v[48:63], v[120:123], v[124:127], v[48:63]
    buffer_load_dwordx4 v140, s[20:23], s49 offen offset:2048 lds
    s_waitcnt lgkmcnt(0)
    v_mfma_f32_32x32x16_bf16 v[16:31], v[64:67], v[76:79], v[16:31]
    ds_read_b128 v[108:111], v130
    ds_read_b64_tr_b16 v[96:97], v134 offset:0
    ds_read_b64_tr_b16 v[98:99], v134 offset:768
    ds_read_b64_tr_b16 v[100:101], v134 offset:64
    s_lshl_b32 s48, s3, 12
    v_mfma_f32_32x32x16_bf16 v[32:47], v[68:71], v[76:79], v[32:47]
    ds_read_b64_tr_b16 v[102:103], v134 offset:832
    ds_read_b64_tr_b16 v[104:105], v134 offset:128
    ds_read_b64_tr_b16 v[106:107], v134 offset:896
    ds_read_b128 v[124:127], v131
    s_add_u32 s48, s48, 16384
    v_mfma_f32_32x32x16_bf16 v[48:63], v[72:75], v[76:79], v[48:63]
    ds_read_b64_tr_b16 v[112:113], v135 offset:0
    ds_read_b64_tr_b16 v[114:115], v135 offset:768
    ds_read_b64_tr_b16 v[116:117], v135 offset:64
    ds_read_b64_tr_b16 v[118:119], v135 offset:832
    s_mov_b32 m0, s48
    s_add_u32 s49, s4, 5
    s_and_b32 s49, s49, 7
    s_lshl_b32 s49, s49, 7
    v_mfma_f32_32x32x16_bf16 v[16:31], v[80:83], v[92:95], v[16:31]
    ds_read_b64_tr_b16 v[120:121], v135 offset:128
    ds_read_b64_tr_b16 v[122:123], v135 offset:896
    buffer_load_dwordx4 v136, s[16:19], s49 offen offset:0 lds
    v_mfma_f32_32x32x16_bf16 v[32:47], v[84:87], v[92:95], v[32:47]
    buffer_load_dwordx4 v137, s[16:19], s49 offen offset:1024 lds
    v_mfma_f32_32x32x16_bf16 v[48:63], v[88:91], v[92:95], v[48:63]
    buffer_load_dwordx4 v136, s[16:19], s49 offen offset:2048 lds
    buffer_load_dwordx4 v137, s[16:19], s49 offen offset:3072 lds
    s_waitcnt vmcnt(11) lgkmcnt(0)
    s_barrier
    v_add_u32 v128, 16384, v128
    v_add_u32 v132, 12288, v132
    v_add_u32 v129, 16384, v129
    v_add_u32 v133, 12288, v133
    v_mfma_f32_32x32x16_bf16 v[16:31], v[96:99], v[108:111], v[16:31]
    ds_read_b128 v[76:79], v128
    ds_read_b64_tr_b16 v[64:65], v132 offset:0
    ds_read_b64_tr_b16 v[66:67], v132 offset:768
    ds_read_b64_tr_b16 v[68:69], v132 offset:64
    ds_read_b64_tr_b16 v[70:71], v132 offset:832
    v_mfma_f32_32x32x16_bf16 v[32:47], v[100:103], v[108:111], v[32:47]
    ds_read_b64_tr_b16 v[72:73], v132 offset:128
    ds_read_b64_tr_b16 v[74:75], v132 offset:896
    ds_read_b128 v[92:95], v129
    ds_read_b64_tr_b16 v[80:81], v133 offset:0
    ds_read_b64_tr_b16 v[82:83], v133 offset:768
    s_mul_i32 s50, s3, 3072
    v_mfma_f32_32x32x16_bf16 v[48:63], v[104:107], v[108:111], v[48:63]
    ds_read_b64_tr_b16 v[84:85], v133 offset:64
    ds_read_b64_tr_b16 v[86:87], v133 offset:832
    ds_read_b64_tr_b16 v[88:89], v133 offset:128
    ds_read_b64_tr_b16 v[90:91], v133 offset:896
    v_add_u32 v130, 16384, v130
    s_add_u32 s50, s50, 77824
    v_mfma_f32_32x32x16_bf16 a[176:191], v[144:147], v[96:99], a[176:191]
    v_add_u32 v134, 12288, v134
    v_add_u32 v131, 16384, v131
    v_add_u32 v135, 12288, v135
    s_mov_b32 m0, s50
    v_mfma_f32_32x32x16_bf16 a[192:207], v[144:147], v[100:103], a[192:207]
    v_mfma_f32_32x32x16_bf16 a[208:223], v[144:147], v[104:107], a[208:223]
    s_add_u32 s49, s4, 5
    s_and_b32 s49, s49, 7
    s_mul_i32 s49, s49, 176128
    v_mfma_f32_32x32x16_bf16 v[16:31], v[112:115], v[124:127], v[16:31]
    buffer_load_dwordx4 v138, s[20:23], s49 offen offset:0 lds
    v_mfma_f32_32x32x16_bf16 v[32:47], v[116:119], v[124:127], v[32:47]
    buffer_load_dwordx4 v139, s[20:23], s49 offen offset:1024 lds
    v_mfma_f32_32x32x16_bf16 v[48:63], v[120:123], v[124:127], v[48:63]
    buffer_load_dwordx4 v140, s[20:23], s49 offen offset:2048 lds
    s_waitcnt lgkmcnt(0)
    v_mfma_f32_32x32x16_bf16 v[16:31], v[64:67], v[76:79], v[16:31]
    ds_read_b128 v[108:111], v130
    ds_read_b64_tr_b16 v[96:97], v134 offset:0
    ds_read_b64_tr_b16 v[98:99], v134 offset:768
    ds_read_b64_tr_b16 v[100:101], v134 offset:64
    s_lshl_b32 s48, s3, 12
    v_mfma_f32_32x32x16_bf16 v[32:47], v[68:71], v[76:79], v[32:47]
    ds_read_b64_tr_b16 v[102:103], v134 offset:832
    ds_read_b64_tr_b16 v[104:105], v134 offset:128
    ds_read_b64_tr_b16 v[106:107], v134 offset:896
    ds_read_b128 v[124:127], v131
    s_add_u32 s48, s48, 32768
    v_mfma_f32_32x32x16_bf16 v[48:63], v[72:75], v[76:79], v[48:63]
    ds_read_b64_tr_b16 v[112:113], v135 offset:0
    ds_read_b64_tr_b16 v[114:115], v135 offset:768
    ds_read_b64_tr_b16 v[116:117], v135 offset:64
    ds_read_b64_tr_b16 v[118:119], v135 offset:832
    s_mov_b32 m0, s48
    s_add_u32 s49, s4, 6
    s_and_b32 s49, s49, 7
    s_lshl_b32 s49, s49, 7
    v_mfma_f32_32x32x16_bf16 v[16:31], v[80:83], v[92:95], v[16:31]
    ds_read_b64_tr_b16 v[120:121], v135 offset:128
    ds_read_b64_tr_b16 v[122:123], v135 offset:896
    buffer_load_dwordx4 v136, s[16:19], s49 offen offset:0 lds
    v_mfma_f32_32x32x16_bf16 v[32:47], v[84:87], v[92:95], v[32:47]
    buffer_load_dwordx4 v137, s[16:19], s49 offen offset:1024 lds
    v_mfma_f32_32x32x16_bf16 v[48:63], v[88:91], v[92:95], v[48:63]
    buffer_load_dwordx4 v136, s[16:19], s49 offen offset:2048 lds
    buffer_load_dwordx4 v137, s[16:19], s49 offen offset:3072 lds
    s_waitcnt vmcnt(11) lgkmcnt(0)
    s_barrier
    v_add_u32 v128, 4294918144, v128
    v_add_u32 v132, 4294930432, v132
    v_add_u32 v129, 4294918144, v129
    v_add_u32 v133, 4294930432, v133
    v_mfma_f32_32x32x16_bf16 v[16:31], v[96:99], v[108:111], v[16:31]
    ds_read_b128 v[76:79], v128
    ds_read_b64_tr_b16 v[64:65], v132 offset:0
    ds_read_b64_tr_b16 v[66:67], v132 offset:768
    ds_read_b64_tr_b16 v[68:69], v132 offset:64
    ds_read_b64_tr_b16 v[70:71], v132 offset:832
    s_mul_i32 s50, s3, 3072
    v_mfma_f32_32x32x16_bf16 v[32:47], v[100:103], v[108:111], v[32:47]
    ds_read_b64_tr_b16 v[72:73], v132 offset:128
    ds_read_b64_tr_b16 v[74:75], v132 offset:896
    ds_read_b128 v[92:95], v129
    ds_read_b64_tr_b16 v[80:81], v133 offset:0
    ds_read_b64_tr_b16 v[82:83], v133 offset:768
    s_add_u32 s50, s50, 90112
    v_mfma_f32_32x32x16_bf16 v[48:63], v[104:107], v[108:111], v[48:63]
    ds_read_b64_tr_b16 v[84:85], v133 offset:64
    ds_read_b64_tr_b16 v[86:87], v133 offset:832
    ds_read_b64_tr_b16 v[88:89], v133 offset:128
    ds_read_b64_tr_b16 v[90:91], v133 offset:896
    v_add_u32 v130, 4294918144, v130
    s_mov_b32 m0, s50
    s_add_u32 s49, s4, 6
    s_and_b32 s49, s49, 7
    s_mul_i32 s49, s49, 176128
    v_mfma_f32_32x32x16_bf16 a[176:191], v[144:147], v[96:99], a[176:191]
    v_add_u32 v134, 4294930432, v134
    v_add_u32 v131, 4294918144, v131
    v_add_u32 v135, 4294930432, v135
    buffer_load_dwordx4 v138, s[20:23], s49 offen offset:0 lds
    v_mfma_f32_32x32x16_bf16 a[192:207], v[144:147], v[100:103], a[192:207]
    buffer_load_dwordx4 v139, s[20:23], s49 offen offset:1024 lds
    v_mfma_f32_32x32x16_bf16 a[208:223], v[144:147], v[104:107], a[208:223]
    buffer_load_dwordx4 v140, s[20:23], s49 offen offset:2048 lds
    s_lshl_b32 s52, s4, 5
    v_mfma_f32_32x32x16_bf16 v[16:31], v[112:115], v[124:127], v[16:31]
    v_add_u32 v2, s52, v1
    v_mfma_f32_32x32x16_bf16 v[32:47], v[116:119], v[124:127], v[32:47]
    v_lshlrev_b32 v2, 7, v2
    v_mfma_f32_32x32x16_bf16 v[48:63], v[120:123], v[124:127], v[48:63]
    v_add_u32 v2, 0xc01000, v2
    s_mov_b64 exec, 0xffffffff
    global_load_dword v3, v2, s[46:47] sc1
    s_mov_b64 exec, -1
    s_waitcnt lgkmcnt(0)
    v_mfma_f32_32x32x16_bf16 v[16:31], v[64:67], v[76:79], v[16:31]
    ds_read_b128 v[108:111], v130
    ds_read_b64_tr_b16 v[96:97], v134 offset:0
    ds_read_b64_tr_b16 v[98:99], v134 offset:768
    ds_read_b64_tr_b16 v[100:101], v134 offset:64
    s_lshl_b32 s48, s3, 12
    s_add_u32 s48, s48, 49152
    v_mfma_f32_32x32x16_bf16 v[32:47], v[68:71], v[76:79], v[32:47]
    ds_read_b64_tr_b16 v[102:103], v134 offset:832
    ds_read_b64_tr_b16 v[104:105], v134 offset:128
    ds_read_b64_tr_b16 v[106:107], v134 offset:896
    ds_read_b128 v[124:127], v131
    s_mov_b32 m0, s48
    s_add_u32 s49, s4, 7
    s_and_b32 s49, s49, 7
    s_lshl_b32 s49, s49, 7
    buffer_load_dwordx4 v136, s[16:19], s49 offen offset:0 lds
    v_mfma_f32_32x32x16_bf16 v[48:63], v[72:75], v[76:79], v[48:63]
    ds_read_b64_tr_b16 v[112:113], v135 offset:0
    ds_read_b64_tr_b16 v[114:115], v135 offset:768
    ds_read_b64_tr_b16 v[116:117], v135 offset:64
    ds_read_b64_tr_b16 v[118:119], v135 offset:832
    buffer_load_dwordx4 v137, s[16:19], s49 offen offset:1024 lds
    buffer_load_dwordx4 v136, s[16:19], s49 offen offset:2048 lds
    buffer_load_dwordx4 v137, s[16:19], s49 offen offset:3072 lds
    v_mfma_f32_32x32x16_bf16 v[16:31], v[80:83], v[92:95], v[16:31]
    ds_read_b64_tr_b16 v[120:121], v135 offset:128
    ds_read_b64_tr_b16 v[122:123], v135 offset:896
    s_lshl_b32 s52, s58, 12
    s_add_u32 s52, s52, 0x200000
    s_add_u32 s12, s46, s52
    s_addc_u32 s13, s47, 0
    s_mov_b32 s14, 8192
    s_mov_b32 s15, 0x20000
    v_add_u32 v157, 1, v156
    s_add_u32 s8, s46, 0x0
    s_addc_u32 s9, s47, 0
    s_mov_b32 s10, 16384
    s_mov_b32 s11, 0x20000
    v_mfma_f32_32x32x16_bf16 v[32:47], v[84:87], v[92:95], v[32:47]
    v_and_b32 v162, 7, v1
    v_lshlrev_b32 v162, 2, v162
    v_bfe_u32 v163, v1, 3, 2
    v_mfma_f32_32x32x16_bf16 v[48:63], v[88:91], v[92:95], v[48:63]
    v_add_u32 v162, v162, v163
    v_lshlrev_b32 v162, 3, v162
    s_lshl_b32 s53, s6, 2
    s_add_u32 s53, s53, s3
    s_lshl_b32 s53, s53, 8
    s_waitcnt vmcnt(12) lgkmcnt(0)
    s_barrier
    v_add_u32 v128, 16384, v128
    v_add_u32 v132, 12288, v132
    v_add_u32 v129, 16384, v129
    v_add_u32 v133, 12288, v133
    v_mfma_f32_32x32x16_bf16 v[16:31], v[96:99], v[108:111], v[16:31]
    ds_read_b128 v[76:79], v128
    ds_read_b64_tr_b16 v[64:65], v132 offset:0
    ds_read_b64_tr_b16 v[66:67], v132 offset:768
    ds_read_b64_tr_b16 v[68:69], v132 offset:64
    ds_read_b64_tr_b16 v[70:71], v132 offset:832
    v_mfma_f32_32x32x16_bf16 v[32:47], v[100:103], v[108:111], v[32:47]
    ds_read_b64_tr_b16 v[72:73], v132 offset:128
    ds_read_b64_tr_b16 v[74:75], v132 offset:896
    ds_read_b128 v[92:95], v129
    ds_read_b64_tr_b16 v[80:81], v133 offset:0
    ds_read_b64_tr_b16 v[82:83], v133 offset:768
    s_mul_i32 s50, s3, 3072
    v_mfma_f32_32x32x16_bf16 v[48:63], v[104:107], v[108:111], v[48:63]
    ds_read_b64_tr_b16 v[84:85], v133 offset:64
    ds_read_b64_tr_b16 v[86:87], v133 offset:832
    ds_read_b64_tr_b16 v[88:89], v133 offset:128
    ds_read_b64_tr_b16 v[90:91], v133 offset:896
    v_add_u32 v130, 16384, v130
    s_add_u32 s50, s50, 102400
    v_mfma_f32_32x32x16_bf16 a[176:191], v[144:147], v[96:99], a[176:191]
    v_add_u32 v134, 12288, v134
    v_add_u32 v131, 16384, v131
    v_add_u32 v135, 12288, v135
    s_mov_b32 m0, s50
    v_mfma_f32_32x32x16_bf16 a[192:207], v[144:147], v[100:103], a[192:207]
    v_mfma_f32_32x32x16_bf16 a[208:223], v[144:147], v[104:107], a[208:223]
    s_add_u32 s49, s4, 7
    s_and_b32 s49, s49, 7
    s_mul_i32 s49, s49, 176128
    v_mfma_f32_32x32x16_bf16 v[16:31], v[112:115], v[124:127], v[16:31]
    buffer_load_dwordx4 v138, s[20:23], s49 offen offset:0 lds
    v_mfma_f32_32x32x16_bf16 v[32:47], v[116:119], v[124:127], v[32:47]
    buffer_load_dwordx4 v139, s[20:23], s49 offen offset:1024 lds
    v_mfma_f32_32x32x16_bf16 v[48:63], v[120:123], v[124:127], v[48:63]
    buffer_load_dwordx4 v140, s[20:23], s49 offen offset:2048 lds
    s_waitcnt lgkmcnt(0)
    v_mfma_f32_32x32x16_bf16 v[16:31], v[64:67], v[76:79], v[16:31]
    ds_read_b128 v[108:111], v130
    ds_read_b64_tr_b16 v[96:97], v134 offset:0
    ds_read_b64_tr_b16 v[98:99], v134 offset:768
    ds_read_b64_tr_b16 v[100:101], v134 offset:64
    v_mfma_f32_32x32x16_bf16 v[32:47], v[68:71], v[76:79], v[32:47]
    ds_read_b64_tr_b16 v[102:103], v134 offset:832
    ds_read_b64_tr_b16 v[104:105], v134 offset:128
    ds_read_b64_tr_b16 v[106:107], v134 offset:896
    ds_read_b128 v[124:127], v131
    v_mfma_f32_32x32x16_bf16 v[48:63], v[72:75], v[76:79], v[48:63]
    ds_read_b64_tr_b16 v[112:113], v135 offset:0
    ds_read_b64_tr_b16 v[114:115], v135 offset:768
    ds_read_b64_tr_b16 v[116:117], v135 offset:64
    ds_read_b64_tr_b16 v[118:119], v135 offset:832
    v_mfma_f32_32x32x16_bf16 v[16:31], v[80:83], v[92:95], v[16:31]
    ds_read_b64_tr_b16 v[120:121], v135 offset:128
    ds_read_b64_tr_b16 v[122:123], v135 offset:896
    v_mfma_f32_32x32x16_bf16 v[32:47], v[84:87], v[92:95], v[32:47]
    v_mfma_f32_32x32x16_bf16 v[48:63], v[88:91], v[92:95], v[48:63]
    s_waitcnt vmcnt(7) lgkmcnt(0)
    s_barrier
    s_mov_b64 exec, 0xffffffff
    v_cmp_ne_u32 vcc, s60, v3
    s_mov_b32 s55, 0
    s_cbranch_vccz L_polld_3
L_poll_2:
    s_sleep 1
    global_load_dword v3, v2, s[46:47] sc1
    s_waitcnt vmcnt(0)
    v_cmp_ne_u32 vcc, s60, v3
    s_add_u32 s55, s55, 1
    s_cbranch_vccz L_polld_3
    s_cmp_lt_u32 s55, 200000
    s_cbranch_scc1 L_poll_2
L_polld_3:
    s_mov_b64 exec, -1
    buffer_load_dwordx2 v[14:15], v162, s[8:11], s53 offen sc1
    buffer_load_dwordx4 v[148:151], v156, s[12:15], 0 offen sc1
    buffer_load_dwordx4 v[152:155], v157, s[12:15], 0 offen offset:4095 sc1
    v_add_u32 v128, 16384, v128
    v_add_u32 v132, 12288, v132
    v_add_u32 v129, 16384, v129
    v_add_u32 v133, 12288, v133
    v_mfma_f32_32x32x16_bf16 v[16:31], v[96:99], v[108:111], v[16:31]
    ds_read_b128 v[76:79], v128
    ds_read_b64_tr_b16 v[64:65], v132 offset:0
    ds_read_b64_tr_b16 v[66:67], v132 offset:768
    ds_read_b64_tr_b16 v[68:69], v132 offset:64
    ds_read_b64_tr_b16 v[70:71], v132 offset:832
    v_mfma_f32_32x32x16_bf16 v[32:47], v[100:103], v[108:111], v[32:47]
    ds_read_b64_tr_b16 v[72:73], v132 offset:128
    ds_read_b64_tr_b16 v[74:75], v132 offset:896
    ds_read_b128 v[92:95], v129
    ds_read_b64_tr_b16 v[80:81], v133 offset:0
    ds_read_b64_tr_b16 v[82:83], v133 offset:768
    v_mfma_f32_32x32x16_bf16 v[48:63], v[104:107], v[108:111], v[48:63]
    ds_read_b64_tr_b16 v[84:85], v133 offset:64
    ds_read_b64_tr_b16 v[86:87], v133 offset:832
    ds_read_b64_tr_b16 v[88:89], v133 offset:128
    ds_read_b64_tr_b16 v[90:91], v133 offset:896
    v_add_u32 v130, 16384, v130
    v_mfma_f32_32x32x16_bf16 a[176:191], v[144:147], v[96:99], a[176:191]
    v_add_u32 v134, 12288, v134
    v_add_u32 v131, 16384, v131
    v_add_u32 v135, 12288, v135
    v_mfma_f32_32x32x16_bf16 a[192:207], v[144:147], v[100:103], a[192:207]
    v_mfma_f32_32x32x16_bf16 a[208:223], v[144:147], v[104:107], a[208:223]
    v_mfma_f32_32x32x16_bf16 v[16:31], v[112:115], v[124:127], v[16:31]
    v_mfma_f32_32x32x16_bf16 v[32:47], v[116:119], v[124:127], v[32:47]
    v_mfma_f32_32x32x16_bf16 v[48:63], v[120:123], v[124:127], v[48:63]
    s_waitcnt lgkmcnt(0)
    v_mfma_f32_32x32x16_bf16 v[16:31], v[64:67], v[76:79], v[16:31]
    ds_read_b128 v[108:111], v130
    ds_read_b64_tr_b16 v[96:97], v134 offset:0
    ds_read_b64_tr_b16 v[98:99], v134 offset:768
    ds_read_b64_tr_b16 v[100:101], v134 offset:64
    s_lshr_b32 s54, s3, 1
    s_add_u32 s54, s54, s58
    s_lshl_b32 s54, s54, 12
    s_add_u32 s16, s32, s54
    s_addc_u32 s17, s33, 0
    s_mov_b32 s18, 4096
    s_mov_b32 s19, 0x20000
    s_and_b32 s55, s3, 1
    s_lshl_b32 s55, s55, 2
    v_lshlrev_b32 v240, 4, v1
    v_add_u32 v240, s55, v240
    v_add_u32 v241, 2, v240
    v_mfma_f32_32x32x16_bf16 v[32:47], v[68:71], v[76:79], v[32:47]
    ds_read_b64_tr_b16 v[102:103], v134 offset:832
    ds_read_b64_tr_b16 v[104:105], v134 offset:128
    ds_read_b64_tr_b16 v[106:107], v134 offset:896
    ds_read_b128 v[124:127], v131
    s_lshr_b32 s54, s3, 1
    s_mul_i32 s54, s54, 16640
    s_and_b32 s55, s3, 1
    s_mul_i32 s55, s55, 8320
    s_add_u32 s54, s54, s55
    s_add_u32 s54, s54, 114720
    s_mov_b32 m0, s54
    s_nop 0
    v_mfma_f32_32x32x16_bf16 v[48:63], v[72:75], v[76:79], v[48:63]
    ds_read_b64_tr_b16 v[112:113], v135 offset:0
    ds_read_b64_tr_b16 v[114:115], v135 offset:768
    ds_read_b64_tr_b16 v[116:117], v135 offset:64
    ds_read_b64_tr_b16 v[118:119], v135 offset:832
    buffer_load_dwordx4 v240, s[16:19], 0 offen offset:0 lds
    buffer_load_dwordx4 v240, s[16:19], 0 offen offset:1024 lds
    v_mfma_f32_32x32x16_bf16 v[16:31], v[80:83], v[92:95], v[16:31]
    ds_read_b64_tr_b16 v[120:121], v135 offset:128
    ds_read_b64_tr_b16 v[122:123], v135 offset:896
    buffer_load_dwordx4 v240, s[16:19], 0 offen offset:2048 lds
    buffer_load_dwordx4 v240, s[16:19], 0 offen offset:3072 lds
    s_add_u32 s54, s54, 4160
    s_mov_b32 m0, s54
    v_mfma_f32_32x32x16_bf16 v[32:47], v[84:87], v[92:95], v[32:47]
    s_nop 0
    buffer_load_dwordx4 v241, s[16:19], 0 offen offset:0 lds
    v_mfma_f32_32x32x16_bf16 v[48:63], v[88:91], v[92:95], v[48:63]
    buffer_load_dwordx4 v241, s[16:19], 0 offen offset:1024 lds
    buffer_load_dwordx4 v241, s[16:19], 0 offen offset:2048 lds
    buffer_load_dwordx4 v241, s[16:19], 0 offen offset:3072 lds
    s_waitcnt vmcnt(11) lgkmcnt(0)
    s_barrier
    v_add_u32 v128, 16384, v128
    v_add_u32 v132, 12288, v132
    v_add_u32 v129, 16384, v129
    v_add_u32 v133, 12288, v133
    v_mfma_f32_32x32x16_bf16 v[16:31], v[96:99], v[108:111], v[16:31]
    ds_read_b128 v[76:79], v128
    ds_read_b64_tr_b16 v[64:65], v132 offset:0
    ds_read_b64_tr_b16 v[66:67], v132 offset:768
    ds_read_b64_tr_b16 v[68:69], v132 offset:64
    ds_read_b64_tr_b16 v[70:71], v132 offset:832
    v_mfma_f32_32x32x16_bf16 v[32:47], v[100:103], v[108:111], v[32:47]
    ds_read_b64_tr_b16 v[72:73], v132 offset:128
    ds_read_b64_tr_b16 v[74:75], v132 offset:896
    ds_read_b128 v[92:95], v129
    ds_read_b64_tr_b16 v[80:81], v133 offset:0
    ds_read_b64_tr_b16 v[82:83], v133 offset:768
    s_lshl_b32 s52, s66, 5
    v_mfma_f32_32x32x16_bf16 v[48:63], v[104:107], v[108:111], v[48:63]
    ds_read_b64_tr_b16 v[84:85], v133 offset:64
    ds_read_b64_tr_b16 v[86:87], v133 offset:832
    ds_read_b64_tr_b16 v[88:89], v133 offset:128
    ds_read_b64_tr_b16 v[90:91], v133 offset:896
    v_add_u32 v130, 16384, v130
    v_mfma_f32_32x32x16_bf16 a[176:191], v[144:147], v[96:99], a[176:191]
    v_add_u32 v134, 12288, v134
    v_add_u32 v131, 16384, v131
    v_add_u32 v135, 12288, v135
    v_add_u32 v250, s52, v1
    v_mfma_f32_32x32x16_bf16 a[192:207], v[144:147], v[100:103], a[192:207]
    v_mfma_f32_32x32x16_bf16 a[208:223], v[144:147], v[104:107], a[208:223]
    v_lshlrev_b32 v250, 7, v250
    v_mfma_f32_32x32x16_bf16 v[16:31], v[112:115], v[124:127], v[16:31]
    v_mfma_f32_32x32x16_bf16 v[32:47], v[116:119], v[124:127], v[32:47]
    v_add_u32 v250, 0xc01000, v250
    v_mfma_f32_32x32x16_bf16 v[48:63], v[120:123], v[124:127], v[48:63]
    s_mov_b64 exec, 0xffffffff
    global_load_dword v251, v250, s[46:47] sc1
    s_mov_b64 exec, -1
    s_waitcnt lgkmcnt(0)
    v_mfma_f32_32x32x16_bf16 v[16:31], v[64:67], v[76:79], v[16:31]
    ds_read_b128 v[108:111], v130
    ds_read_b64_tr_b16 v[96:97], v134 offset:0
    ds_read_b64_tr_b16 v[98:99], v134 offset:768
    ds_read_b64_tr_b16 v[100:101], v134 offset:64
    v_mfma_f32_32x32x16_bf16 v[32:47], v[68:71], v[76:79], v[32:47]
    ds_read_b64_tr_b16 v[102:103], v134 offset:832
    ds_read_b64_tr_b16 v[104:105], v134 offset:128
    ds_read_b64_tr_b16 v[106:107], v134 offset:896
    ds_read_b128 v[124:127], v131
    v_mfma_f32_32x32x16_bf16 v[48:63], v[72:75], v[76:79], v[48:63]
    ds_read_b64_tr_b16 v[112:113], v135 offset:0
    ds_read_b64_tr_b16 v[114:115], v135 offset:768
    ds_read_b64_tr_b16 v[116:117], v135 offset:64
    ds_read_b64_tr_b16 v[118:119], v135 offset:832
    v_mfma_f32_32x32x16_bf16 a[176:191], v[144:147], v[64:67], a[176:191]
    ds_read_b64_tr_b16 v[120:121], v135 offset:128
    ds_read_b64_tr_b16 v[122:123], v135 offset:896
    v_mfma_f32_32x32x16_bf16 a[192:207], v[144:147], v[68:71], a[192:207]
    v_mfma_f32_32x32x16_bf16 a[208:223], v[144:147], v[72:75], a[208:223]
    v_mfma_f32_32x32x16_bf16 v[16:31], v[80:83], v[92:95], v[16:31]
    v_mfma_f32_32x32x16_bf16 v[32:47], v[84:87], v[92:95], v[32:47]
    v_mfma_f32_32x32x16_bf16 v[48:63], v[88:91], v[92:95], v[48:63]
    v_and_b32 v2, 31, v1
    v_lshlrev_b32 v2, 2, v2
    v_add_u32 v2, 157184, v2
    s_mul_i32 s52, s3, 384
    v_add_u32 v3, s52, v2
    v_accvgpr_read_b32 v140, a176
    s_nop 1
    v_accvgpr_read_b32 v141, a192
    v_accvgpr_read_b32 v142, a208
    ds_write_b32 v3, v140 offset:0
    ds_write_b32 v3, v141 offset:128
    ds_write_b32 v3, v142 offset:256
    s_waitcnt lgkmcnt(0)
    s_barrier
    ds_read_b32 v196, v2 offset:0
    ds_read_b32 v197, v2 offset:128
    ds_read_b32 v198, v2 offset:256
    ds_read_b32 v199, v2 offset:384
    ds_read_b32 v200, v2 offset:512
    ds_read_b32 v201, v2 offset:640
    ds_read_b32 v202, v2 offset:768
    ds_read_b32 v203, v2 offset:896
    ds_read_b32 v204, v2 offset:1024
    ds_read_b32 v205, v2 offset:1152
    ds_read_b32 v206, v2 offset:1280
    ds_read_b32 v207, v2 offset:1408
    v_mfma_f32_32x32x16_bf16 v[16:31], v[96:99], v[108:111], v[16:31]
    v_mfma_f32_32x32x16_bf16 v[32:47], v[100:103], v[108:111], v[32:47]
    s_waitcnt lgkmcnt(0)
    v_mfma_f32_32x32x16_bf16 v[48:63], v[104:107], v[108:111], v[48:63]
    v_add_f32 v196, v196, v199
    v_add_f32 v202, v202, v205
    v_add_f32 v197, v197, v200
    v_add_f32 v203, v203, v206
    v_add_f32 v198, v198, v201
    v_add_f32 v204, v204, v207
    v_add_f32 v196, v196, v202
    v_add_f32 v197, v197, v203
    v_mfma_f32_32x32x16_bf16 v[16:31], v[112:115], v[124:127], v[16:31]
    v_add_f32 v198, v198, v204
    ds_write_b32 v3, v196 offset:1536
    ds_write_b32 v3, v197 offset:1664
    ds_write_b32 v3, v198 offset:1792
    v_lshrrev_b32 v2, 5, v1
    v_lshlrev_b32 v2, 4, v2
    v_add_u32 v2, 158720, v2
    v_add_u32 v2, s52, v2
    v_mfma_f32_32x32x16_bf16 v[32:47], v[116:119], v[124:127], v[32:47]
    ds_read_b128 v[64:67], v2 offset:0
    ds_read_b128 v[68:71], v2 offset:32
    ds_read_b128 v[72:75], v2 offset:64
    ds_read_b128 v[76:79], v2 offset:96
    ds_read_b128 v[80:83], v2 offset:128
    ds_read_b128 v[84:87], v2 offset:160
    ds_read_b128 v[88:91], v2 offset:192
    ds_read_b128 v[92:95], v2 offset:224
    v_mfma_f32_32x32x16_bf16 v[48:63], v[120:123], v[124:127], v[48:63]
    ds_read_b128 v[208:211], v2 offset:256
    ds_read_b128 v[212:215], v2 offset:288
    ds_read_b128 v[216:219], v2 offset:320
    ds_read_b128 v[220:223], v2 offset:352
    s_cmp_lg_u32 s3, 0
    s_cbranch_scc1 L_toep_4
    v_mov_b32 v192, 0
    v_mov_b32 v193, 0
    v_mov_b32 v194, 0
    v_mov_b32 v195, 0
    v_lshrrev_b32 v184, 3, v1
    v_mul_u32_u24 v184, 16640, v184
    v_bfe_u32 v185, v1, 1, 2
    v_mul_u32_u24 v185, 4160, v185
    v_add_u32 v184, v184, v185
    v_and_b32 v185, 1, v1
    v_lshl_add_u32 v184, v185, 4, v184
    v_add_u32 v184, 114688, v184
    s_mov_b64 exec, 0xffff
    ds_write_b128 v184, v[192:195]
    s_mov_b64 exec, 1
    v_mov_b32 v186, 114688
    v_mov_b32 v189, s92
    v_mov_b32 v190, s93
    v_alignbyte_b32 v187, v189, v192, 2
    v_alignbyte_b32 v188, v190, v189, 2
    ds_write_b32 v186, v189 offset:8348
    ds_write_b32 v186, v187 offset:4188
    ds_write_b32 v186, v187 offset:12504
    ds_write_b32 v186, v188 offset:12508
    v_mov_b32 v189, s94
    v_mov_b32 v190, s95
    v_alignbyte_b32 v187, v189, v192, 2
    v_alignbyte_b32 v188, v190, v189, 2
    ds_write_b32 v186, v189 offset:24988
    ds_write_b32 v186, v187 offset:20828
    ds_write_b32 v186, v187 offset:29144
    ds_write_b32 v186, v188 offset:29148
    s_mov_b64 exec, -1
L_toep_4:
    s_waitcnt vmcnt(11)
    v_sub_f32 v112, 0, v14
    v_mov_b32 v113, v112
    s_add_u32 s16, s46, 0x400000
    s_addc_u32 s17, s47, 0
    s_mov_b32 s18, 0x560000
    s_mov_b32 s19, 0x20000
    s_lshl_b32 s48, s6, 2
    s_add_u32 s48, s48, s3
    s_mul_i32 s48, s48, 86
    s_lshl_b32 s49, s59, 1
    s_add_u32 s48, s48, s49
    s_lshl_b32 s56, s48, 10
    s_add_u32 s55, s56, 4096
    v_lshlrev_b32 v114, 4, v1
    s_waitcnt lgkmcnt(0)
    v_pk_fma_f32 v[16:17], v[64:65], v[112:113], v[16:17]
    v_pk_fma_f32 v[18:19], v[66:67], v[112:113], v[18:19]
    v_pk_fma_f32 v[20:21], v[68:69], v[112:113], v[20:21]
    v_pk_fma_f32 v[22:23], v[70:71], v[112:113], v[22:23]
    v_pk_fma_f32 v[24:25], v[72:73], v[112:113], v[24:25]
    v_pk_fma_f32 v[26:27], v[74:75], v[112:113], v[26:27]
    v_pk_fma_f32 v[28:29], v[76:77], v[112:113], v[28:29]
    v_pk_fma_f32 v[30:31], v[78:79], v[112:113], v[30:31]
    v_cvt_pk_bf16_f32 v116, v16, v17
    v_cvt_pk_bf16_f32 v117, v18, v19
    v_cvt_pk_bf16_f32 v118, v20, v21
    v_cvt_pk_bf16_f32 v119, v22, v23
    v_cvt_pk_bf16_f32 v120, v24, v25
    v_cvt_pk_bf16_f32 v121, v26, v27
    v_cvt_pk_bf16_f32 v122, v28, v29
    v_cvt_pk_bf16_f32 v123, v30, v31
    v_pk_max_i16 v116, v116, 0
    v_pk_max_i16 v117, v117, 0
    v_pk_max_i16 v118, v118, 0
    v_pk_max_i16 v119, v119, 0
    v_pk_max_i16 v120, v120, 0
    v_pk_max_i16 v121, v121, 0
    v_pk_max_i16 v122, v122, 0
    v_pk_max_i16 v123, v123, 0
    buffer_store_dwordx4 v[116:119], v114, s[16:19], s56 offen offset:0 sc0 sc1
    buffer_store_dwordx4 v[120:123], v114, s[16:19], s56 offen offset:1024 sc0 sc1
    v_pk_fma_f32 v[32:33], v[80:81], v[112:113], v[32:33]
    v_pk_fma_f32 v[34:35], v[82:83], v[112:113], v[34:35]
    v_pk_fma_f32 v[36:37], v[84:85], v[112:113], v[36:37]
    v_pk_fma_f32 v[38:39], v[86:87], v[112:113], v[38:39]
    v_pk_fma_f32 v[40:41], v[88:89], v[112:113], v[40:41]
    v_pk_fma_f32 v[42:43], v[90:91], v[112:113], v[42:43]
    v_pk_fma_f32 v[44:45], v[92:93], v[112:113], v[44:45]
    v_pk_fma_f32 v[46:47], v[94:95], v[112:113], v[46:47]
    v_cvt_pk_bf16_f32 v124, v32, v33
    v_cvt_pk_bf16_f32 v125, v34, v35
    v_cvt_pk_bf16_f32 v126, v36, v37
    v_cvt_pk_bf16_f32 v127, v38, v39
    v_cvt_pk_bf16_f32 v128, v40, v41
    v_cvt_pk_bf16_f32 v129, v42, v43
    v_cvt_pk_bf16_f32 v130, v44, v45
    v_cvt_pk_bf16_f32 v131, v46, v47
    v_pk_max_i16 v124, v124, 0
    v_pk_max_i16 v125, v125, 0
    v_pk_max_i16 v126, v126, 0
    v_pk_max_i16 v127, v127, 0
    v_pk_max_i16 v128, v128, 0
    v_pk_max_i16 v129, v129, 0
    v_pk_max_i16 v130, v130, 0
    v_pk_max_i16 v131, v131, 0
    buffer_store_dwordx4 v[124:127], v114, s[16:19], s56 offen offset:2048 sc0 sc1
    buffer_store_dwordx4 v[128:131], v114, s[16:19], s56 offen offset:3072 sc0 sc1
    s_cmp_ge_u32 s7, 11
    s_cselect_b32 s55, 0x7f000000, s55
    v_pk_fma_f32 v[48:49], v[208:209], v[112:113], v[48:49]
    v_pk_fma_f32 v[50:51], v[210:211], v[112:113], v[50:51]
    v_pk_fma_f32 v[52:53], v[212:213], v[112:113], v[52:53]
    v_pk_fma_f32 v[54:55], v[214:215], v[112:113], v[54:55]
    v_pk_fma_f32 v[56:57], v[216:217], v[112:113], v[56:57]
    v_pk_fma_f32 v[58:59], v[218:219], v[112:113], v[58:59]
    v_pk_fma_f32 v[60:61], v[220:221], v[112:113], v[60:61]
    v_pk_fma_f32 v[62:63], v[222:223], v[112:113], v[62:63]
    v_cvt_pk_bf16_f32 v132, v48, v49
    v_cvt_pk_bf16_f32 v133, v50, v51
    v_cvt_pk_bf16_f32 v134, v52, v53
    v_cvt_pk_bf16_f32 v135, v54, v55
    v_cvt_pk_bf16_f32 v136, v56, v57
    v_cvt_pk_bf16_f32 v137, v58, v59
    v_cvt_pk_bf16_f32 v138, v60, v61
    v_cvt_pk_bf16_f32 v139, v62, v63
    v_pk_max_i16 v132, v132, 0
    v_pk_max_i16 v133, v133, 0
    v_pk_max_i16 v134, v134, 0
    v_pk_max_i16 v135, v135, 0
    v_pk_max_i16 v136, v136, 0
    v_pk_max_i16 v137, v137, 0
    v_pk_max_i16 v138, v138, 0
    v_pk_max_i16 v139, v139, 0
    buffer_store_dwordx4 v[132:135], v114, s[16:19], s55 offen offset:0 sc0 sc1
    buffer_store_dwordx4 v[136:139], v114, s[16:19], s55 offen offset:1024 sc0 sc1
L_g1s_5:
    s_waitcnt vmcnt(15)
    v_add_u32 v157, 147968, v156
    ds_write_b128 v157, v[148:151]
    ds_write_b128 v157, v[152:155] offset:4608
    v_mov_b32 v164, 0
    v_mov_b32 v165, 0
    v_mov_b32 v166, 0
    v_mov_b32 v167, 0
    v_lshrrev_b32 v168, 5, v1
    v_mul_u32_u24 v168, 4608, v168
    v_and_b32 v169, 31, v1
    v_lshl_add_u32 v168, v169, 4, v168
    v_add_u32 v168, 152064, v168
    ds_write_b128 v168, v[164:167]
    s_waitcnt vmcnt(7)
    s_waitcnt lgkmcnt(0)
    s_barrier
    ds_read_b128 v[176:179], v9 offset:3584
    ds_read_b64 v[144:145], v8 offset:0
    ds_read_b64 v[146:147], v8 offset:8
    ds_read_b64 v[148:149], v8 offset:512
    ds_read_b64 v[150:151], v8 offset:520
    ds_read_b64 v[152:153], v8 offset:1024
    ds_read_b64 v[154:155], v8 offset:1032
    ds_read_b64 v[156:157], v8 offset:1536
    ds_read_b64 v[158:159], v8 offset:1544
    ds_read_b64 v[160:161], v8 offset:2048
    ds_read_b64 v[162:163], v8 offset:2056
    ds_read_b64 v[164:165], v8 offset:2560
    ds_read_b64 v[166:167], v8 offset:2568
    ds_read_b64 v[168:169], v8 offset:3072
    ds_read_b64 v[170:171], v8 offset:3080
    ds_read_b64 v[172:173], v8 offset:3584
    ds_read_b64 v[174:175], v8 offset:3592
    ds_read_b128 v[180:183], v9 offset:3072
    ds_read_b128 v[184:187], v9 offset:2560
    ds_read_b128 v[188:191], v9 offset:2048
    ds_read_b128 v[192:195], v9 offset:1536
    ds_read_b128 v[196:199], v9 offset:1024
    ds_read_b128 v[200:203], v9 offset:512
    ds_read_b128 v[204:207], v9 offset:0
    s_waitcnt lgkmcnt(0)
    v_mfma_f32_16x16x32_bf16 v[208:211], v[144:147], v[176:179], 0
    ds_read_b128 v[96:99], v9 offset:3648
    v_mfma_f32_16x16x32_bf16 v[212:215], v[148:151], v[176:179], 0
    ds_read_b64 v[64:65], v8 offset:64
    v_mfma_f32_16x16x32_bf16 v[216:219], v[152:155], v[176:179], 0
    ds_read_b64 v[66:67], v8 offset:72
    v_mfma_f32_16x16x32_bf16 v[220:223], v[156:159], v[176:179], 0
    ds_read_b64 v[68:69], v8 offset:576
    v_mfma_f32_16x16x32_bf16 v[224:227], v[160:163], v[176:179], 0
    ds_read_b64 v[70:71], v8 offset:584
    v_mfma_f32_16x16x32_bf16 v[228:231], v[164:167], v[176:179], 0
    ds_read_b64 v[72:73], v8 offset:1088
    v_mfma_f32_16x16x32_bf16 v[232:235], v[168:171], v[176:179], 0
    ds_read_b64 v[74:75], v8 offset:1096
    v_mfma_f32_16x16x32_bf16 v[236:239], v[172:175], v[176:179], 0
    ds_read_b64 v[76:77], v8 offset:1600
    v_mfma_f32_16x16x32_bf16 v[212:215], v[144:147], v[180:183], v[212:215]
    ds_read_b64 v[78:79], v8 offset:1608
    v_mfma_f32_16x16x32_bf16 v[216:219], v[148:151], v[180:183], v[216:219]
    ds_read_b64 v[80:81], v8 offset:2112
    v_mfma_f32_16x16x32_bf16 v[220:223], v[152:155], v[180:183], v[220:223]
    ds_read_b64 v[82:83], v8 offset:2120
    v_mfma_f32_16x16x32_bf16 v[224:227], v[156:159], v[180:183], v[224:227]
    ds_read_b64 v[84:85], v8 offset:2624
    v_mfma_f32_16x16x32_bf16 v[228:231], v[160:163], v[180:183], v[228:231]
    ds_read_b64 v[86:87], v8 offset:2632
    v_mfma_f32_16x16x32_bf16 v[232:235], v[164:167], v[180:183], v[232:235]
    ds_read_b64 v[88:89], v8 offset:3136
    v_mfma_f32_16x16x32_bf16 v[236:239], v[168:171], v[180:183], v[236:239]
    ds_read_b64 v[90:91], v8 offset:3144
    v_mfma_f32_16x16x32_bf16 v[216:219], v[144:147], v[184:187], v[216:219]
    ds_read_b64 v[92:93], v8 offset:3648
    v_mfma_f32_16x16x32_bf16 v[220:223], v[148:151], v[184:187], v[220:223]
    ds_read_b64 v[94:95], v8 offset:3656
    v_mfma_f32_16x16x32_bf16 v[224:227], v[152:155], v[184:187], v[224:227]
    ds_read_b128 v[100:103], v9 offset:3136
    v_mfma_f32_16x16x32_bf16 v[228:231], v[156:159], v[184:187], v[228:231]
    ds_read_b128 v[104:107], v9 offset:2624
    v_mfma_f32_16x16x32_bf16 v[232:235], v[160:163], v[184:187], v[232:235]
    ds_read_b128 v[108:111], v9 offset:2112
    s_waitcnt vmcnt(0)
    s_barrier
    s_cmp_lg_u32 s3, 0
    s_cbranch_scc1 L_pub_6
    s_lshl_b32 s48, s4, 5
    s_add_u32 s48, s48, s5
    s_lshl_b32 s48, s48, 7
    s_add_u32 s48, s48, 0xc09000
    v_mov_b32 v2, s48
    v_mov_b32 v3, s60
    s_mov_b64 exec, 1
    global_store_dword v2, v3, s[46:47] sc0 sc1
    s_mov_b64 exec, -1
L_pub_6:
    s_mov_b64 exec, 0xffffffff
    v_cmp_ne_u32 vcc, s60, v251
    s_mov_b32 s55, 0
    s_cbranch_vccz L_polld_8
L_poll_7:
    s_sleep 1
    global_load_dword v251, v250, s[46:47] sc1
    s_waitcnt vmcnt(0)
    v_cmp_ne_u32 vcc, s60, v251
    s_add_u32 s55, s55, 1
    s_cbranch_vccz L_polld_8
    s_cmp_lt_u32 s55, 200000
    s_cbranch_scc1 L_poll_7
L_polld_8:
    s_mov_b64 exec, -1
    s_mul_i32 s48, s66, 176128
    s_add_u32 s48, s48, 0xe00000
    s_add_u32 s12, s46, s48
    s_addc_u32 s13, s47, 0
    s_mov_b32 s14, 176128
    s_mov_b32 s15, 0x20000
    s_mov_b32 s62, s57
    v_mfma_f32_16x16x32_bf16 v[236:239], v[164:167], v[184:187], v[236:239]
    ds_read_b128 v[112:115], v9 offset:1600
    v_mfma_f32_16x16x32_bf16 v[220:223], v[144:147], v[188:191], v[220:223]
    ds_read_b128 v[116:119], v9 offset:1088
    s_add_u32 s51, s67, s62
    s_lshl_b32 s51, s51, 11
    v_mfma_f32_16x16x32_bf16 v[224:227], v[148:151], v[188:191], v[224:227]
    ds_read_b128 v[120:123], v9 offset:576
    buffer_load_dwordx4 a[0:3], v143, s[12:15], s51 offen offset:0 sc1
    v_mfma_f32_16x16x32_bf16 v[228:231], v[152:155], v[188:191], v[228:231]
    ds_read_b128 v[124:127], v9 offset:64
    s_add_u32 s62, s62, 2
    s_cmp_eq_u32 s62, s63
    s_cselect_b32 s62, 0, s62
    v_mfma_f32_16x16x32_bf16 v[232:235], v[156:159], v[188:191], v[232:235]
    v_mfma_f32_16x16x32_bf16 v[236:239], v[160:163], v[188:191], v[236:239]
    buffer_load_dwordx4 a[4:7], v143, s[12:15], s51 offen offset:1024 sc1
    v_mfma_f32_16x16x32_bf16 v[224:227], v[144:147], v[192:195], v[224:227]
    buffer_load_dwordx4 a[8:11], v143, s[12:15], s51 offen offset:2048 sc1
    v_mfma_f32_16x16x32_bf16 v[228:231], v[148:151], v[192:195], v[228:231]
    buffer_load_dwordx4 a[12:15], v143, s[12:15], s51 offen offset:3072 sc1
    v_mfma_f32_16x16x32_bf16 v[232:235], v[152:155], v[192:195], v[232:235]
    v_mfma_f32_16x16x32_bf16 v[236:239], v[156:159], v[192:195], v[236:239]
    s_add_u32 s51, s67, s62
    s_lshl_b32 s51, s51, 11
    v_mfma_f32_16x16x32_bf16 v[228:231], v[144:147], v[196:199], v[228:231]
    buffer_load_dwordx4 a[16:19], v143, s[12:15], s51 offen offset:0 sc1
    v_mfma_f32_16x16x32_bf16 v[232:235], v[148:151], v[196:199], v[232:235]
    s_add_u32 s62, s62, 2
    s_cmp_eq_u32 s62, s63
    s_cselect_b32 s62, 0, s62
    v_mfma_f32_16x16x32_bf16 v[236:239], v[152:155], v[196:199], v[236:239]
    v_mfma_f32_16x16x32_bf16 v[232:235], v[144:147], v[200:203], v[232:235]
    buffer_load_dwordx4 a[20:23], v143, s[12:15], s51 offen offset:1024 sc1
    v_mfma_f32_16x16x32_bf16 v[236:239], v[148:151], v[200:203], v[236:239]
    buffer_load_dwordx4 a[24:27], v143, s[12:15], s51 offen offset:2048 sc1
    v_mfma_f32_16x16x32_bf16 v[236:239], v[144:147], v[204:207], v[236:239]
    buffer_load_dwordx4 a[28:31], v143, s[12:15], s51 offen offset:3072 sc1
    s_waitcnt lgkmcnt(0)
    v_mfma_f32_16x16x32_bf16 v[208:211], v[64:67], v[96:99], v[208:211]
    ds_read_b128 v[176:179], v9 offset:3712
    v_mfma_f32_16x16x32_bf16 v[212:215], v[68:71], v[96:99], v[212:215]
    ds_read_b64 v[144:145], v8 offset:128
    s_add_u32 s51, s67, s62
    s_lshl_b32 s51, s51, 11
    v_mfma_f32_16x16x32_bf16 v[216:219], v[72:75], v[96:99], v[216:219]
    ds_read_b64 v[146:147], v8 offset:136
    buffer_load_dwordx4 a[32:35], v143, s[12:15], s51 offen offset:0 sc1
    v_mfma_f32_16x16x32_bf16 v[220:223], v[76:79], v[96:99], v[220:223]
    ds_read_b64 v[148:149], v8 offset:640
    s_add_u32 s62, s62, 2
    s_cmp_eq_u32 s62, s63
    s_cselect_b32 s62, 0, s62
    v_mfma_f32_16x16x32_bf16 v[224:227], v[80:83], v[96:99], v[224:227]
    ds_read_b64 v[150:151], v8 offset:648
    buffer_load_dwordx4 a[36:39], v143, s[12:15], s51 offen offset:1024 sc1
    v_mfma_f32_16x16x32_bf16 v[228:231], v[84:87], v[96:99], v[228:231]
    ds_read_b64 v[152:153], v8 offset:1152
    buffer_load_dwordx4 a[40:43], v143, s[12:15], s51 offen offset:2048 sc1
    v_mfma_f32_16x16x32_bf16 v[232:235], v[88:91], v[96:99], v[232:235]
    ds_read_b64 v[154:155], v8 offset:1160
    v_mfma_f32_16x16x32_bf16 v[236:239], v[92:95], v[96:99], v[236:239]
    ds_read_b64 v[156:157], v8 offset:1664
    buffer_load_dwordx4 a[44:47], v143, s[12:15], s51 offen offset:3072 sc1
    v_mfma_f32_16x16x32_bf16 v[212:215], v[64:67], v[100:103], v[212:215]
    ds_read_b64 v[158:159], v8 offset:1672
    s_add_u32 s51, s67, s62
    s_lshl_b32 s51, s51, 11
    v_mfma_f32_16x16x32_bf16 v[216:219], v[68:71], v[100:103], v[216:219]
    ds_read_b64 v[160:161], v8 offset:2176
    buffer_load_dwordx4 a[48:51], v143, s[12:15], s51 offen offset:0 sc1
    v_mfma_f32_16x16x32_bf16 v[220:223], v[72:75], v[100:103], v[220:223]
    ds_read_b64 v[162:163], v8 offset:2184
    s_add_u32 s62, s62, 2
    s_cmp_eq_u32 s62, s63
    s_cselect_b32 s62, 0, s62
    v_mfma_f32_16x16x32_bf16 v[224:227], v[76:79], v[100:103], v[224:227]
    ds_read_b64 v[164:165], v8 offset:2688
    buffer_load_dwordx4 a[52:55], v143, s[12:15], s51 offen offset:1024 sc1
    v_mfma_f32_16x16x32_bf16 v[228:231], v[80:83], v[100:103], v[228:231]
    ds_read_b64 v[166:167], v8 offset:2696
    v_mfma_f32_16x16x32_bf16 v[232:235], v[84:87], v[100:103], v[232:235]
    ds_read_b64 v[168:169], v8 offset:3200
    buffer_load_dwordx4 a[56:59], v143, s[12:15], s51 offen offset:2048 sc1
    v_mfma_f32_16x16x32_bf16 v[236:239], v[88:91], v[100:103], v[236:239]
    ds_read_b64 v[170:171], v8 offset:3208
    buffer_load_dwordx4 a[60:63], v143, s[12:15], s51 offen offset:3072 sc1
    v_mfma_f32_16x16x32_bf16 v[216:219], v[64:67], v[104:107], v[216:219]
    ds_read_b64 v[172:173], v8 offset:3712
    s_add_u32 s51, s67, s62
    s_lshl_b32 s51, s51, 11
    v_mfma_f32_16x16x32_bf16 v[220:223], v[68:71], v[104:107], v[220:223]
    ds_read_b64 v[174:175], v8 offset:3720
    buffer_load_dwordx4 a[64:67], v143, s[12:15], s51 offen offset:0 sc1
    v_mfma_f32_16x16x32_bf16 v[224:227], v[72:75], v[104:107], v[224:227]
    ds_read_b128 v[180:183], v9 offset:3200
    s_add_u32 s62, s62, 2
    s_cmp_eq_u32 s62, s63
    s_cselect_b32 s62, 0, s62
    v_mfma_f32_16x16x32_bf16 v[228:231], v[76:79], v[104:107], v[228:231]
    ds_read_b128 v[184:187], v9 offset:2688
    v_mfma_f32_16x16x32_bf16 v[232:235], v[80:83], v[104:107], v[232:235]
    ds_read_b128 v[188:191], v9 offset:2176
    buffer_load_dwordx4 a[68:71], v143, s[12:15], s51 offen offset:1024 sc1
    v_mfma_f32_16x16x32_bf16 v[236:239], v[84:87], v[104:107], v[236:239]
    ds_read_b128 v[192:195], v9 offset:1664
    buffer_load_dwordx4 a[72:75], v143, s[12:15], s51 offen offset:2048 sc1
    v_mfma_f32_16x16x32_bf16 v[220:223], v[64:67], v[108:111], v[220:223]
    ds_read_b128 v[196:199], v9 offset:1152
    buffer_load_dwordx4 a[76:79], v143, s[12:15], s51 offen offset:3072 sc1
    v_mfma_f32_16x16x32_bf16 v[224:227], v[68:71], v[108:111], v[224:227]
    ds_read_b128 v[200:203], v9 offset:640
    s_add_u32 s51, s67, s62
    s_lshl_b32 s51, s51, 11
    v_mfma_f32_16x16x32_bf16 v[228:231], v[72:75], v[108:111], v[228:231]
    ds_read_b128 v[204:207], v9 offset:128
    buffer_load_dwordx4 a[80:83], v143, s[12:15], s51 offen offset:0 sc1
    v_mfma_f32_16x16x32_bf16 v[232:235], v[76:79], v[108:111], v[232:235]
    v_mfma_f32_16x16x32_bf16 v[236:239], v[80:83], v[108:111], v[236:239]
    s_add_u32 s62, s62, 2
    s_cmp_eq_u32 s62, s63
    s_cselect_b32 s62, 0, s62
    v_mfma_f32_16x16x32_bf16 v[224:227], v[64:67], v[112:115], v[224:227]
    buffer_load_dwordx4 a[84:87], v143, s[12:15], s51 offen offset:1024 sc1
    v_mfma_f32_16x16x32_bf16 v[228:231], v[68:71], v[112:115], v[228:231]
    buffer_load_dwordx4 a[88:91], v143, s[12:15], s51 offen offset:2048 sc1
    v_mfma_f32_16x16x32_bf16 v[232:235], v[72:75], v[112:115], v[232:235]
    buffer_load_dwordx4 a[92:95], v143, s[12:15], s51 offen offset:3072 sc1
    v_mfma_f32_16x16x32_bf16 v[236:239], v[76:79], v[112:115], v[236:239]
    s_add_u32 s51, s67, s62
    s_lshl_b32 s51, s51, 11
    v_mfma_f32_16x16x32_bf16 v[228:231], v[64:67], v[116:119], v[228:231]
    v_mfma_f32_16x16x32_bf16 v[232:235], v[68:71], v[116:119], v[232:235]
    buffer_load_dwordx4 a[96:99], v143, s[12:15], s51 offen offset:0 sc1
    v_mfma_f32_16x16x32_bf16 v[236:239], v[72:75], v[116:119], v[236:239]
    s_add_u32 s62, s62, 2
    s_cmp_eq_u32 s62, s63
    s_cselect_b32 s62, 0, s62
    v_mfma_f32_16x16x32_bf16 v[232:235], v[64:67], v[120:123], v[232:235]
    buffer_load_dwordx4 a[100:103], v143, s[12:15], s51 offen offset:1024 sc1
    v_mfma_f32_16x16x32_bf16 v[236:239], v[68:71], v[120:123], v[236:239]
    buffer_load_dwordx4 a[104:107], v143, s[12:15], s51 offen offset:2048 sc1
    v_mfma_f32_16x16x32_bf16 v[236:239], v[64:67], v[124:127], v[236:239]
    buffer_load_dwordx4 a[108:111], v143, s[12:15], s51 offen offset:3072 sc1
    s_waitcnt lgkmcnt(0)
    s_and_b32 s54, s5, 1
    s_lshl_b32 s48, s4, 5
    s_add_u32 s48, s48, s54
    v_mul_u32_u24 v2, 2, v1
    v_add_u32 v2, s48, v2
    v_lshlrev_b32 v2, 7, v2
    v_add_u32 v2, 0xc09000, v2
    s_mov_b64 exec, 0xffff
    global_load_dword v3, v2, s[46:47] sc1
    s_mov_b64 exec, -1
    v_mfma_f32_16x16x32_bf16 v[208:211], v[144:147], v[176:179], v[208:211]
    ds_read_b128 v[96:99], v9 offset:3776
    v_mfma_f32_16x16x32_bf16 v[212:215], v[148:151], v[176:179], v[212:215]
    ds_read_b64 v[64:65], v8 offset:192
    s_add_u32 s51, s67, s62
    s_lshl_b32 s51, s51, 11
    v_mfma_f32_16x16x32_bf16 v[216:219], v[152:155], v[176:179], v[216:219]
    ds_read_b64 v[66:67], v8 offset:200
    buffer_load_dwordx4 a[112:115], v143, s[12:15], s51 offen offset:0 sc1
    v_mfma_f32_16x16x32_bf16 v[220:223], v[156:159], v[176:179], v[220:223]
    ds_read_b64 v[68:69], v8 offset:704
    v_mfma_f32_16x16x32_bf16 v[224:227], v[160:163], v[176:179], v[224:227]
    ds_read_b64 v[70:71], v8 offset:712
    s_add_u32 s62, s62, 2
    s_cmp_eq_u32 s62, s63
    s_cselect_b32 s62, 0, s62
    v_mfma_f32_16x16x32_bf16 v[228:231], v[164:167], v[176:179], v[228:231]
    ds_read_b64 v[72:73], v8 offset:1216
    buffer_load_dwordx4 a[116:119], v143, s[12:15], s51 offen offset:1024 sc1
    v_mfma_f32_16x16x32_bf16 v[232:235], v[168:171], v[176:179], v[232:235]
    ds_read_b64 v[74:75], v8 offset:1224
    v_mfma_f32_16x16x32_bf16 v[236:239], v[172:175], v[176:179], v[236:239]
    ds_read_b64 v[76:77], v8 offset:1728
    buffer_load_dwordx4 a[120:123], v143, s[12:15], s51 offen offset:2048 sc1
    v_mfma_f32_16x16x32_bf16 v[212:215], v[144:147], v[180:183], v[212:215]
    ds_read_b64 v[78:79], v8 offset:1736
    buffer_load_dwordx4 a[124:127], v143, s[12:15], s51 offen offset:3072 sc1
    v_mfma_f32_16x16x32_bf16 v[216:219], v[148:151], v[180:183], v[216:219]
    ds_read_b64 v[80:81], v8 offset:2240
    v_mfma_f32_16x16x32_bf16 v[220:223], v[152:155], v[180:183], v[220:223]
    ds_read_b64 v[82:83], v8 offset:2248
    s_add_u32 s51, s67, s62
    s_lshl_b32 s51, s51, 11
    v_mfma_f32_16x16x32_bf16 v[224:227], v[156:159], v[180:183], v[224:227]
    ds_read_b64 v[84:85], v8 offset:2752
    buffer_load_dwordx4 a[128:131], v143, s[12:15], s51 offen offset:0 sc1
    v_mfma_f32_16x16x32_bf16 v[228:231], v[160:163], v[180:183], v[228:231]
    ds_read_b64 v[86:87], v8 offset:2760
    v_mfma_f32_16x16x32_bf16 v[232:235], v[164:167], v[180:183], v[232:235]
    ds_read_b64 v[88:89], v8 offset:3264
    s_add_u32 s62, s62, 2
    s_cmp_eq_u32 s62, s63
    s_cselect_b32 s62, 0, s62
    v_mfma_f32_16x16x32_bf16 v[236:239], v[168:171], v[180:183], v[236:239]
    ds_read_b64 v[90:91], v8 offset:3272
    buffer_load_dwordx4 a[132:135], v143, s[12:15], s51 offen offset:1024 sc1
    v_mfma_f32_16x16x32_bf16 v[216:219], v[144:147], v[184:187], v[216:219]
    ds_read_b64 v[92:93], v8 offset:3776
    v_mfma_f32_16x16x32_bf16 v[220:223], v[148:151], v[184:187], v[220:223]
    ds_read_b64 v[94:95], v8 offset:3784
    buffer_load_dwordx4 a[136:139], v143, s[12:15], s51 offen offset:2048 sc1
    v_mfma_f32_16x16x32_bf16 v[224:227], v[152:155], v[184:187], v[224:227]
    ds_read_b128 v[100:103], v9 offset:3264
    buffer_load_dwordx4 a[140:143], v143, s[12:15], s51 offen offset:3072 sc1
    v_mfma_f32_16x16x32_bf16 v[228:231], v[156:159], v[184:187], v[228:231]
    ds_read_b128 v[104:107], v9 offset:2752
    v_mfma_f32_16x16x32_bf16 v[232:235], v[160:163], v[184:187], v[232:235]
    ds_read_b128 v[108:111], v9 offset:2240
    s_add_u32 s51, s67, s62
    s_lshl_b32 s51, s51, 11
    v_mfma_f32_16x16x32_bf16 v[236:239], v[164:167], v[184:187], v[236:239]
    ds_read_b128 v[112:115], v9 offset:1728
    buffer_load_dwordx4 a[144:147], v143, s[12:15], s51 offen offset:0 sc1
    v_mfma_f32_16x16x32_bf16 v[220:223], v[144:147], v[188:191], v[220:223]
    ds_read_b128 v[116:119], v9 offset:1216
    v_mfma_f32_16x16x32_bf16 v[224:227], v[148:151], v[188:191], v[224:227]
    ds_read_b128 v[120:123], v9 offset:704
    s_add_u32 s62, s62, 2
    s_cmp_eq_u32 s62, s63
    s_cselect_b32 s62, 0, s62
    v_mfma_f32_16x16x32_bf16 v[228:231], v[152:155], v[188:191], v[228:231]
    ds_read_b128 v[124:127], v9 offset:192
    buffer_load_dwordx4 a[148:151], v143, s[12:15], s51 offen offset:1024 sc1
    v_mfma_f32_16x16x32_bf16 v[232:235], v[156:159], v[188:191], v[232:235]
    v_mfma_f32_16x16x32_bf16 v[236:239], v[160:163], v[188:191], v[236:239]
    buffer_load_dwordx4 a[152:155], v143, s[12:15], s51 offen offset:2048 sc1
    v_mfma_f32_16x16x32_bf16 v[224:227], v[144:147], v[192:195], v[224:227]
    buffer_load_dwordx4 a[156:159], v143, s[12:15], s51 offen offset:3072 sc1
    v_mfma_f32_16x16x32_bf16 v[228:231], v[148:151], v[192:195], v[228:231]
    v_mfma_f32_16x16x32_bf16 v[232:235], v[152:155], v[192:195], v[232:235]
    s_add_u32 s51, s67, s62
    s_lshl_b32 s51, s51, 11
    v_mfma_f32_16x16x32_bf16 v[236:239], v[156:159], v[192:195], v[236:239]
    buffer_load_dwordx4 a[160:163], v143, s[12:15], s51 offen offset:0 sc1
    v_mfma_f32_16x16x32_bf16 v[228:231], v[144:147], v[196:199], v[228:231]
    v_mfma_f32_16x16x32_bf16 v[232:235], v[148:151], v[196:199], v[232:235]
    s_add_u32 s62, s62, 2
    s_cmp_eq_u32 s62, s63
    s_cselect_b32 s62, 0, s62
    v_mfma_f32_16x16x32_bf16 v[236:239], v[152:155], v[196:199], v[236:239]
    buffer_load_dwordx4 a[164:167], v143, s[12:15], s51 offen offset:1024 sc1
    v_mfma_f32_16x16x32_bf16 v[232:235], v[144:147], v[200:203], v[232:235]
    v_mfma_f32_16x16x32_bf16 v[236:239], v[148:151], v[200:203], v[236:239]
    buffer_load_dwordx4 a[168:171], v143, s[12:15], s51 offen offset:2048 sc1
    v_mfma_f32_16x16x32_bf16 v[236:239], v[144:147], v[204:207], v[236:239]
    buffer_load_dwordx4 a[172:175], v143, s[12:15], s51 offen offset:3072 sc1
    s_waitcnt lgkmcnt(0)
    s_waitcnt vmcnt(16)
    s_mov_b64 exec, 0xffff
    v_cmp_ne_u32 vcc, s60, v3
    s_mov_b32 s55, 0
    s_cbranch_vccz L_polld_10
L_poll_9:
    s_sleep 1
    global_load_dword v3, v2, s[46:47] sc1
    s_waitcnt vmcnt(0)
    v_cmp_ne_u32 vcc, s60, v3
    s_add_u32 s55, s55, 1
    s_cbranch_vccz L_polld_10
    s_cmp_lt_u32 s55, 200000
    s_cbranch_scc1 L_poll_9
L_polld_10:
    s_mov_b64 exec, -1
    s_lshl_b32 s48, s65, 1
    s_add_u32 s48, s48, 0
    s_mul_i32 s48, s48, 88064
    s_add_u32 s48, s48, 0x400000
    s_add_u32 s16, s46, s48
    s_addc_u32 s17, s47, 0
    s_mov_b32 s18, 88064
    s_mov_b32 s19, 0x20000
    s_lshl_b32 s48, s65, 1
    s_add_u32 s48, s48, 1
    s_mul_i32 s48, s48, 88064
    s_add_u32 s48, s48, 0x400000
    s_add_u32 s20, s46, s48
    s_addc_u32 s21, s47, 0
    s_mov_b32 s22, 88064
    s_mov_b32 s23, 0x20000
    v_lshlrev_b32 v13, 4, v1
    s_mov_b32 s62, s57
    v_mfma_f32_16x16x32_bf16 v[208:211], v[64:67], v[96:99], v[208:211]
    v_mfma_f32_16x16x32_bf16 v[212:215], v[68:71], v[96:99], v[212:215]
    s_add_u32 s50, s67, s62
    s_lshl_b32 s50, s50, 10
    v_mfma_f32_16x16x32_bf16 v[216:219], v[72:75], v[96:99], v[216:219]
    v_lshlrev_b32 v160, 4, v1
    v_mfma_f32_16x16x32_bf16 v[220:223], v[76:79], v[96:99], v[220:223]
    buffer_load_dwordx4 v[16:19], v13, s[16:19], s50 offen offset:0 sc1
    v_mfma_f32_16x16x32_bf16 v[224:227], v[80:83], v[96:99], v[224:227]
    s_lshl_b32 s52, s3, 13
    v_mfma_f32_16x16x32_bf16 v[228:231], v[84:87], v[96:99], v[228:231]
    s_add_u32 s62, s62, 2
    s_cmp_eq_u32 s62, s63
    s_cselect_b32 s62, 0, s62
    v_mfma_f32_16x16x32_bf16 v[232:235], v[88:91], v[96:99], v[232:235]
    v_add_u32 v161, s52, v160
    v_mfma_f32_16x16x32_bf16 v[236:239], v[92:95], v[96:99], v[236:239]
    buffer_load_dwordx4 v[20:23], v13, s[20:23], s50 offen offset:0 sc1
    v_mfma_f32_16x16x32_bf16 v[212:215], v[64:67], v[100:103], v[212:215]
    s_lshl_b32 s52, s3, 11
    v_mfma_f32_16x16x32_bf16 v[216:219], v[68:71], v[100:103], v[216:219]
    buffer_load_dwordx4 v[24:27], v13, s[16:19], s50 offen offset:1024 sc1
    v_mfma_f32_16x16x32_bf16 v[220:223], v[72:75], v[100:103], v[220:223]
    v_add_u32 v166, s52, v160
    v_mfma_f32_16x16x32_bf16 v[224:227], v[76:79], v[100:103], v[224:227]
    buffer_load_dwordx4 v[28:31], v13, s[20:23], s50 offen offset:1024 sc1
    v_mfma_f32_16x16x32_bf16 v[228:231], v[80:83], v[100:103], v[228:231]
    v_and_b32 v162, 15, v1
    v_mfma_f32_16x16x32_bf16 v[232:235], v[84:87], v[100:103], v[232:235]
    s_add_u32 s50, s67, s62
    s_lshl_b32 s50, s50, 10
    v_mfma_f32_16x16x32_bf16 v[236:239], v[88:91], v[100:103], v[236:239]
    v_lshrrev_b32 v163, 4, v1
    v_mfma_f32_16x16x32_bf16 v[216:219], v[64:67], v[104:107], v[216:219]
    buffer_load_dwordx4 v[32:35], v13, s[16:19], s50 offen offset:0 sc1
    v_mfma_f32_16x16x32_bf16 v[220:223], v[68:71], v[104:107], v[220:223]
    v_lshlrev_b32 v164, 5, v162
    v_mfma_f32_16x16x32_bf16 v[224:227], v[72:75], v[104:107], v[224:227]
    s_add_u32 s62, s62, 2
    s_cmp_eq_u32 s62, s63
    s_cselect_b32 s62, 0, s62
    v_mfma_f32_16x16x32_bf16 v[228:231], v[76:79], v[104:107], v[228:231]
    v_mfma_f32_16x16x32_bf16 v[232:235], v[80:83], v[104:107], v[232:235]
    buffer_load_dwordx4 v[36:39], v13, s[20:23], s50 offen offset:0 sc1
    v_mfma_f32_16x16x32_bf16 v[236:239], v[84:87], v[104:107], v[236:239]
    v_lshl_add_u32 v164, v163, 3, v164
    v_mfma_f32_16x16x32_bf16 v[220:223], v[64:67], v[108:111], v[220:223]
    buffer_load_dwordx4 v[40:43], v13, s[16:19], s50 offen offset:1024 sc1
    v_mfma_f32_16x16x32_bf16 v[224:227], v[68:71], v[108:111], v[224:227]
    s_lshl_b32 s52, s3, 10
    s_sub_u32 s52, 151544, s52
    v_mfma_f32_16x16x32_bf16 v[228:231], v[72:75], v[108:111], v[228:231]
    buffer_load_dwordx4 v[44:47], v13, s[20:23], s50 offen offset:1024 sc1
    v_mfma_f32_16x16x32_bf16 v[232:235], v[76:79], v[108:111], v[232:235]
    v_sub_u32 v164, s52, v164
    v_mfma_f32_16x16x32_bf16 v[236:239], v[80:83], v[108:111], v[236:239]
    s_add_u32 s50, s67, s62
    s_lshl_b32 s50, s50, 10
    v_mfma_f32_16x16x32_bf16 v[224:227], v[64:67], v[112:115], v[224:227]
    v_lshlrev_b32 v165, 6, v162
    v_mfma_f32_16x16x32_bf16 v[228:231], v[68:71], v[112:115], v[228:231]
    buffer_load_dwordx4 v[48:51], v13, s[16:19], s50 offen offset:0 sc1
    v_mfma_f32_16x16x32_bf16 v[232:235], v[72:75], v[112:115], v[232:235]
    v_lshl_add_u32 v165, v163, 4, v165
    v_mfma_f32_16x16x32_bf16 v[236:239], v[76:79], v[112:115], v[236:239]
    s_add_u32 s62, s62, 2
    s_cmp_eq_u32 s62, s63
    s_cselect_b32 s62, 0, s62
    v_mfma_f32_16x16x32_bf16 v[228:231], v[64:67], v[116:119], v[228:231]
    s_add_u32 s8, s46, 0xa00000
    s_addc_u32 s9, s47, 0
    s_mov_b32 s10, 0x200000
    s_mov_b32 s11, 0x20000
    v_mfma_f32_16x16x32_bf16 v[232:235], v[68:71], v[116:119], v[232:235]
    buffer_load_dwordx4 v[52:55], v13, s[20:23], s50 offen offset:0 sc1
    v_mfma_f32_16x16x32_bf16 v[236:239], v[72:75], v[116:119], v[236:239]
    s_lshl_b32 s53, s58, 12
    s_lshl_b32 s52, s3, 11
    s_add_u32 s53, s53, s52
    v_mfma_f32_16x16x32_bf16 v[232:235], v[64:67], v[120:123], v[232:235]
    buffer_load_dwordx4 v[56:59], v13, s[16:19], s50 offen offset:1024 sc1
    v_mfma_f32_16x16x32_bf16 v[236:239], v[68:71], v[120:123], v[236:239]
    s_lshl_b32 s55, s71, 16
    s_and_b32 s54, s71, 0xffff0000
    v_mfma_f32_16x16x32_bf16 v[236:239], v[64:67], v[124:127], v[236:239]
    buffer_load_dwordx4 v[60:63], v13, s[20:23], s50 offen offset:1024 sc1
    ds_write_b128 v161, v[208:211] offset:0
    ds_write_b128 v161, v[212:215] offset:1024
    s_add_u32 s50, s67, s62
    s_lshl_b32 s50, s50, 10
    ds_write_b128 v161, v[216:219] offset:2048
    buffer_load_dwordx4 v[128:131], v13, s[16:19], s50 offen offset:0 sc1
    ds_write_b128 v161, v[220:223] offset:3072
    s_add_u32 s62, s62, 2
    s_cmp_eq_u32 s62, s63
    s_cselect_b32 s62, 0, s62
    ds_write_b128 v161, v[224:227] offset:4096
    ds_write_b128 v161, v[228:231] offset:5120
    buffer_load_dwordx4 v[132:135], v13, s[20:23], s50 offen offset:0 sc1
    ds_write_b128 v161, v[232:235] offset:6144
    buffer_load_dwordx4 v[136:139], v13, s[16:19], s50 offen offset:1024 sc1
    ds_write_b128 v161, v[236:239] offset:7168
    buffer_load_dwordx4 v[140:143], v13, s[20:23], s50 offen offset:1024 sc1
    s_waitcnt lgkmcnt(0)
    s_barrier
    ds_read_b128 v[64:67], v166 offset:0
    ds_read_b128 v[68:71], v166 offset:8192
    s_add_u32 s50, s67, s62
    s_lshl_b32 s50, s50, 10
    ds_read_b128 v[72:75], v166 offset:16384
    ds_read_b128 v[76:79], v166 offset:24576
    buffer_load_dwordx4 v[240:243], v13, s[16:19], s50 offen offset:0 sc1
    ds_read_b128 v[80:83], v166 offset:1024
    ds_read_b128 v[84:87], v166 offset:9216
    s_add_u32 s62, s62, 2
    s_cmp_eq_u32 s62, s63
    s_cselect_b32 s62, 0, s62
    ds_read_b128 v[88:91], v166 offset:17408
    ds_read_b128 v[92:95], v166 offset:25600
    buffer_load_dwordx4 v[244:247], v13, s[20:23], s50 offen offset:0 sc1
    ds_read_b64 v[96:97], v164 offset:512
    ds_read_b64 v[98:99], v164 offset:5120
    buffer_load_dwordx4 v[248:251], v13, s[16:19], s50 offen offset:1024 sc1
    ds_read_b64 v[100:101], v164 offset:0
    ds_read_b64 v[102:103], v164 offset:4608
    buffer_load_dwordx4 v[252:255], v13, s[20:23], s50 offen offset:1024 sc1
    s_waitcnt lgkmcnt(0)
    v_pk_add_f32 v[64:65], v[64:65], v[68:69]
    v_pk_add_f32 v[66:67], v[66:67], v[70:71]
    v_and_b32 v104, 0xffff0000, v97
    v_lshlrev_b32 v105, 16, v97
    v_and_b32 v106, 0xffff0000, v96
    v_lshlrev_b32 v107, 16, v96
    v_mul_f32 v104, s55, v104
    v_mul_f32 v105, s55, v105
    v_mul_f32 v106, s55, v106
    v_mul_f32 v107, s55, v107
    v_cvt_pk_bf16_f32 v168, v64, v65
    v_cvt_pk_bf16_f32 v170, v104, v105
    v_cvt_pk_bf16_f32 v169, v66, v67
    v_cvt_pk_bf16_f32 v171, v106, v107
    v_lshlrev_b32 v64, 16, v168
    v_and_b32 v65, 0xffff0000, v168
    v_lshlrev_b32 v66, 16, v169
    v_and_b32 v67, 0xffff0000, v169
    v_lshlrev_b32 v104, 16, v170
    v_and_b32 v105, 0xffff0000, v170
    v_lshlrev_b32 v106, 16, v171
    v_and_b32 v107, 0xffff0000, v171
    v_pk_add_f32 v[64:65], v[64:65], v[104:105]
    v_pk_add_f32 v[66:67], v[66:67], v[106:107]
    v_pk_add_f32 v[72:73], v[72:73], v[76:77]
    v_pk_add_f32 v[74:75], v[74:75], v[78:79]
    v_and_b32 v104, 0xffff0000, v99
    v_lshlrev_b32 v105, 16, v99
    v_and_b32 v106, 0xffff0000, v98
    v_lshlrev_b32 v107, 16, v98
    v_mul_f32 v104, s54, v104
    v_mul_f32 v105, s54, v105
    v_mul_f32 v106, s54, v106
    v_mul_f32 v107, s54, v107
    v_cvt_pk_bf16_f32 v168, v72, v73
    v_cvt_pk_bf16_f32 v170, v104, v105
    v_cvt_pk_bf16_f32 v169, v74, v75
    v_cvt_pk_bf16_f32 v171, v106, v107
    v_lshlrev_b32 v72, 16, v168
    v_and_b32 v73, 0xffff0000, v168
    v_lshlrev_b32 v74, 16, v169
    v_and_b32 v75, 0xffff0000, v169
    v_lshlrev_b32 v104, 16, v170
    v_and_b32 v105, 0xffff0000, v170
    v_lshlrev_b32 v106, 16, v171
    v_and_b32 v107, 0xffff0000, v171
    v_pk_add_f32 v[72:73], v[72:73], v[104:105]
    v_pk_add_f32 v[74:75], v[74:75], v[106:107]
    v_cvt_pk_bf16_f32 v120, v64, v72
    v_cvt_pk_bf16_f32 v121, v65, v73
    v_cvt_pk_bf16_f32 v122, v66, v74
    v_cvt_pk_bf16_f32 v123, v67, v75
    v_pk_add_f32 v[80:81], v[80:81], v[84:85]
    v_pk_add_f32 v[82:83], v[82:83], v[86:87]
    v_and_b32 v104, 0xffff0000, v101
    v_lshlrev_b32 v105, 16, v101
    v_and_b32 v106, 0xffff0000, v100
    v_lshlrev_b32 v107, 16, v100
    v_mul_f32 v104, s55, v104
    v_mul_f32 v105, s55, v105
    v_mul_f32 v106, s55, v106
    v_mul_f32 v107, s55, v107
    v_cvt_pk_bf16_f32 v168, v80, v81
    v_cvt_pk_bf16_f32 v170, v104, v105
    v_cvt_pk_bf16_f32 v169, v82, v83
    v_cvt_pk_bf16_f32 v171, v106, v107
    v_lshlrev_b32 v80, 16, v168
    v_and_b32 v81, 0xffff0000, v168
    v_lshlrev_b32 v82, 16, v169
    v_and_b32 v83, 0xffff0000, v169
    v_lshlrev_b32 v104, 16, v170
    v_and_b32 v105, 0xffff0000, v170
    v_lshlrev_b32 v106, 16, v171
    v_and_b32 v107, 0xffff0000, v171
    v_pk_add_f32 v[80:81], v[80:81], v[104:105]
    v_pk_add_f32 v[82:83], v[82:83], v[106:107]
    v_pk_add_f32 v[88:89], v[88:89], v[92:93]
    v_pk_add_f32 v[90:91], v[90:91], v[94:95]
    v_and_b32 v104, 0xffff0000, v103
    v_lshlrev_b32 v105, 16, v103
    v_and_b32 v106, 0xffff0000, v102
    v_lshlrev_b32 v107, 16, v102
    v_mul_f32 v104, s54, v104
    v_mul_f32 v105, s54, v105
    v_mul_f32 v106, s54, v106
    v_mul_f32 v107, s54, v107
    v_cvt_pk_bf16_f32 v168, v88, v89
    v_cvt_pk_bf16_f32 v170, v104, v105
    v_cvt_pk_bf16_f32 v169, v90, v91
    v_cvt_pk_bf16_f32 v171, v106, v107
    v_lshlrev_b32 v88, 16, v168
    v_and_b32 v89, 0xffff0000, v168
    v_lshlrev_b32 v90, 16, v169
    v_and_b32 v91, 0xffff0000, v169
    v_lshlrev_b32 v104, 16, v170
    v_and_b32 v105, 0xffff0000, v170
    v_lshlrev_b32 v106, 16, v171
    v_and_b32 v107, 0xffff0000, v171
    v_pk_add_f32 v[88:89], v[88:89], v[104:105]
    v_pk_add_f32 v[90:91], v[90:91], v[106:107]
    v_cvt_pk_bf16_f32 v124, v80, v88
    v_cvt_pk_bf16_f32 v125, v81, v89
    v_cvt_pk_bf16_f32 v126, v82, v90
    v_cvt_pk_bf16_f32 v127, v83, v91
    buffer_store_dwordx4 v[120:123], v165, s[8:11], s53 offen sc0 sc1
    buffer_store_dwordx4 v[124:127], v165, s[8:11], s53 offen offset:1024 sc0 sc1
    s_waitcnt vmcnt(20)
    s_waitcnt vmcnt(63)
    v_mfma_f32_32x32x16_bf16 a[176:191], a[0:3], v[16:19], 0
    v_mfma_f32_32x32x16_bf16 a[192:207], a[0:3], v[20:23], 0
    v_mfma_f32_32x32x16_bf16 a[208:223], a[4:7], v[16:19], 0
    v_mfma_f32_32x32x16_bf16 a[224:239], a[4:7], v[20:23], 0
    s_waitcnt vmcnt(18)
    v_mfma_f32_32x32x16_bf16 a[176:191], a[8:11], v[24:27], a[176:191]
    v_mfma_f32_32x32x16_bf16 a[192:207], a[8:11], v[28:31], a[192:207]
    v_mfma_f32_32x32x16_bf16 a[208:223], a[12:15], v[24:27], a[208:223]
    v_mfma_f32_32x32x16_bf16 a[224:239], a[12:15], v[28:31], a[224:239]
    s_waitcnt vmcnt(16)
    v_mfma_f32_32x32x16_bf16 a[176:191], a[16:19], v[32:35], a[176:191]
    v_mfma_f32_32x32x16_bf16 a[192:207], a[16:19], v[36:39], a[192:207]
    v_mfma_f32_32x32x16_bf16 a[208:223], a[20:23], v[32:35], a[208:223]
    v_mfma_f32_32x32x16_bf16 a[224:239], a[20:23], v[36:39], a[224:239]
    s_waitcnt vmcnt(14)
    v_mfma_f32_32x32x16_bf16 a[176:191], a[24:27], v[40:43], a[176:191]
    v_mfma_f32_32x32x16_bf16 a[192:207], a[24:27], v[44:47], a[192:207]
    v_mfma_f32_32x32x16_bf16 a[208:223], a[28:31], v[40:43], a[208:223]
    v_mfma_f32_32x32x16_bf16 a[224:239], a[28:31], v[44:47], a[224:239]
    s_waitcnt vmcnt(0)
    s_barrier
    s_cmp_lg_u32 s3, 0
    s_cbranch_scc1 L_pub_12
    s_lshl_b32 s48, s4, 5
    s_add_u32 s48, s48, s5
    s_lshl_b32 s48, s48, 7
    s_add_u32 s48, s48, 0xc11000
    v_mov_b32 v2, s48
    v_mov_b32 v3, s60
    s_mov_b64 exec, 1
    global_store_dword v2, v3, s[46:47] sc0 sc1
    s_mov_b64 exec, -1
L_pub_12:
    s_waitcnt vmcnt(12)
    v_mfma_f32_32x32x16_bf16 a[176:191], a[32:35], v[48:51], a[176:191]
    s_add_u32 s50, s67, s62
    s_lshl_b32 s50, s50, 10
    v_mfma_f32_32x32x16_bf16 a[192:207], a[32:35], v[52:55], a[192:207]
    buffer_load_dwordx4 v[64:67], v13, s[16:19], s50 offen offset:0 sc1
    v_mfma_f32_32x32x16_bf16 a[208:223], a[36:39], v[48:51], a[208:223]
    s_add_u32 s62, s62, 2
    s_cmp_eq_u32 s62, s63
    s_cselect_b32 s62, 0, s62
    v_mfma_f32_32x32x16_bf16 a[224:239], a[36:39], v[52:55], a[224:239]
    buffer_load_dwordx4 v[68:71], v13, s[20:23], s50 offen offset:0 sc1
    s_waitcnt vmcnt(12)
    v_mfma_f32_32x32x16_bf16 a[176:191], a[40:43], v[56:59], a[176:191]
    v_mfma_f32_32x32x16_bf16 a[192:207], a[40:43], v[60:63], a[192:207]
    buffer_load_dwordx4 v[72:75], v13, s[16:19], s50 offen offset:1024 sc1
    v_mfma_f32_32x32x16_bf16 a[208:223], a[44:47], v[56:59], a[208:223]
    v_mfma_f32_32x32x16_bf16 a[224:239], a[44:47], v[60:63], a[224:239]
    buffer_load_dwordx4 v[76:79], v13, s[20:23], s50 offen offset:1024 sc1
    s_waitcnt vmcnt(12)
    v_mfma_f32_32x32x16_bf16 a[176:191], a[48:51], v[128:131], a[176:191]
    s_add_u32 s50, s67, s62
    s_lshl_b32 s50, s50, 10
    v_mfma_f32_32x32x16_bf16 a[192:207], a[48:51], v[132:135], a[192:207]
    buffer_load_dwordx4 v[80:83], v13, s[16:19], s50 offen offset:0 sc1
    v_mfma_f32_32x32x16_bf16 a[208:223], a[52:55], v[128:131], a[208:223]
    s_add_u32 s62, s62, 2
    s_cmp_eq_u32 s62, s63
    s_cselect_b32 s62, 0, s62
    v_mfma_f32_32x32x16_bf16 a[224:239], a[52:55], v[132:135], a[224:239]
    buffer_load_dwordx4 v[84:87], v13, s[20:23], s50 offen offset:0 sc1
    s_waitcnt vmcnt(12)
    v_mfma_f32_32x32x16_bf16 a[176:191], a[56:59], v[136:139], a[176:191]
    v_mfma_f32_32x32x16_bf16 a[192:207], a[56:59], v[140:143], a[192:207]
    buffer_load_dwordx4 v[88:91], v13, s[16:19], s50 offen offset:1024 sc1
    v_mfma_f32_32x32x16_bf16 a[208:223], a[60:63], v[136:139], a[208:223]
    v_mfma_f32_32x32x16_bf16 a[224:239], a[60:63], v[140:143], a[224:239]
    buffer_load_dwordx4 v[92:95], v13, s[20:23], s50 offen offset:1024 sc1
    s_waitcnt vmcnt(12)
    v_mfma_f32_32x32x16_bf16 a[176:191], a[64:67], v[240:243], a[176:191]
    s_add_u32 s50, s67, s62
    s_lshl_b32 s50, s50, 10
    v_mfma_f32_32x32x16_bf16 a[192:207], a[64:67], v[244:247], a[192:207]
    buffer_load_dwordx4 v[96:99], v13, s[16:19], s50 offen offset:0 sc1
    v_mfma_f32_32x32x16_bf16 a[208:223], a[68:71], v[240:243], a[208:223]
    s_add_u32 s62, s62, 2
    s_cmp_eq_u32 s62, s63
    s_cselect_b32 s62, 0, s62
    v_mfma_f32_32x32x16_bf16 a[224:239], a[68:71], v[244:247], a[224:239]
    buffer_load_dwordx4 v[100:103], v13, s[20:23], s50 offen offset:0 sc1
    s_waitcnt vmcnt(12)
    v_mfma_f32_32x32x16_bf16 a[176:191], a[72:75], v[248:251], a[176:191]
    v_mfma_f32_32x32x16_bf16 a[192:207], a[72:75], v[252:255], a[192:207]
    buffer_load_dwordx4 v[104:107], v13, s[16:19], s50 offen offset:1024 sc1
    v_mfma_f32_32x32x16_bf16 a[208:223], a[76:79], v[248:251], a[208:223]
    v_mfma_f32_32x32x16_bf16 a[224:239], a[76:79], v[252:255], a[224:239]
    buffer_load_dwordx4 v[108:111], v13, s[20:23], s50 offen offset:1024 sc1
    s_waitcnt vmcnt(10)
    v_mfma_f32_32x32x16_bf16 a[176:191], a[80:83], v[64:67], a[176:191]
    s_add_u32 s50, s67, s62
    s_lshl_b32 s50, s50, 10
    v_mfma_f32_32x32x16_bf16 a[192:207], a[80:83], v[68:71], a[192:207]
    buffer_load_dwordx4 v[112:115], v13, s[16:19], s50 offen offset:0 sc1
    v_mfma_f32_32x32x16_bf16 a[208:223], a[84:87], v[64:67], a[208:223]
    s_add_u32 s62, s62, 2
    s_cmp_eq_u32 s62, s63
    s_cselect_b32 s62, 0, s62
    v_mfma_f32_32x32x16_bf16 a[224:239], a[84:87], v[68:71], a[224:239]
    buffer_load_dwordx4 v[116:119], v13, s[20:23], s50 offen offset:0 sc1
    s_waitcnt vmcnt(10)
    v_mfma_f32_32x32x16_bf16 a[176:191], a[88:91], v[72:75], a[176:191]
    v_mfma_f32_32x32x16_bf16 a[192:207], a[88:91], v[76:79], a[192:207]
    buffer_load_dwordx4 v[120:123], v13, s[16:19], s50 offen offset:1024 sc1
    v_mfma_f32_32x32x16_bf16 a[208:223], a[92:95], v[72:75], a[208:223]
    v_mfma_f32_32x32x16_bf16 a[224:239], a[92:95], v[76:79], a[224:239]
    buffer_load_dwordx4 v[124:127], v13, s[20:23], s50 offen offset:1024 sc1
    s_waitcnt vmcnt(10)
    v_mfma_f32_32x32x16_bf16 a[176:191], a[96:99], v[80:83], a[176:191]
    s_add_u32 s50, s67, s62
    s_lshl_b32 s50, s50, 10
    v_mfma_f32_32x32x16_bf16 a[192:207], a[96:99], v[84:87], a[192:207]
    buffer_load_dwordx4 v[128:131], v13, s[16:19], s50 offen offset:0 sc1
    v_mfma_f32_32x32x16_bf16 a[208:223], a[100:103], v[80:83], a[208:223]
    s_add_u32 s62, s62, 2
    s_cmp_eq_u32 s62, s63
    s_cselect_b32 s62, 0, s62
    v_mfma_f32_32x32x16_bf16 a[224:239], a[100:103], v[84:87], a[224:239]
    buffer_load_dwordx4 v[132:135], v13, s[20:23], s50 offen offset:0 sc1
    s_mov_b32 s12, s24
    s_mov_b32 s13, s25
    s_mov_b32 s14, 0x200000
    s_mov_b32 s15, 0x20000
    s_lshl_b32 s52, s65, 16
    s_lshl_b32 s53, s66, 7
    s_add_u32 s52, s52, s53
    s_add_u32 s53, s52, 0x8000
    s_waitcnt vmcnt(10)
    v_mfma_f32_32x32x16_bf16 a[176:191], a[104:107], v[88:91], a[176:191]
    v_mfma_f32_32x32x16_bf16 a[192:207], a[104:107], v[92:95], a[192:207]
    buffer_load_dwordx4 v[136:139], v13, s[16:19], s50 offen offset:1024 sc1
    v_mfma_f32_32x32x16_bf16 a[208:223], a[108:111], v[88:91], a[208:223]
    v_mfma_f32_32x32x16_bf16 a[224:239], a[108:111], v[92:95], a[224:239]
    buffer_load_dwordx4 v[140:143], v13, s[20:23], s50 offen offset:1024 sc1
    s_waitcnt vmcnt(10)
    v_mfma_f32_32x32x16_bf16 a[176:191], a[112:115], v[96:99], a[176:191]
    s_add_u32 s50, s67, s62
    s_lshl_b32 s50, s50, 10
    v_mfma_f32_32x32x16_bf16 a[192:207], a[112:115], v[100:103], a[192:207]
    buffer_load_dwordx4 v[144:147], v13, s[16:19], s50 offen offset:0 sc1
    v_mfma_f32_32x32x16_bf16 a[208:223], a[116:119], v[96:99], a[208:223]
    s_add_u32 s62, s62, 2
    s_cmp_eq_u32 s62, s63
    s_cselect_b32 s62, 0, s62
    v_mfma_f32_32x32x16_bf16 a[224:239], a[116:119], v[100:103], a[224:239]
    buffer_load_dwordx4 v[148:151], v13, s[20:23], s50 offen offset:0 sc1
    s_waitcnt vmcnt(10)
    v_mfma_f32_32x32x16_bf16 a[176:191], a[120:123], v[104:107], a[176:191]
    v_mfma_f32_32x32x16_bf16 a[192:207], a[120:123], v[108:111], a[192:207]
    buffer_load_dwordx4 v[152:155], v13, s[16:19], s50 offen offset:1024 sc1
    v_mfma_f32_32x32x16_bf16 a[208:223], a[124:127], v[104:107], a[208:223]
    v_mfma_f32_32x32x16_bf16 a[224:239], a[124:127], v[108:111], a[224:239]
    buffer_load_dwordx4 v[156:159], v13, s[20:23], s50 offen offset:1024 sc1
    s_waitcnt vmcnt(10)
    v_mfma_f32_32x32x16_bf16 a[176:191], a[128:131], v[112:115], a[176:191]
    v_mfma_f32_32x32x16_bf16 a[192:207], a[128:131], v[116:119], a[192:207]
    v_mfma_f32_32x32x16_bf16 a[208:223], a[132:135], v[112:115], a[208:223]
    v_mfma_f32_32x32x16_bf16 a[224:239], a[132:135], v[116:119], a[224:239]
    buffer_load_dwordx4 v[208:211], v7, s[12:15], s52 offen
    buffer_load_dwordx4 v[212:215], v7, s[12:15], s53 offen
    s_mov_b32 s8, s46
    s_mov_b32 s9, s47
    s_mov_b32 s10, 0x4000
    s_mov_b32 s11, 0x20000
    s_lshl_b32 s48, s65, 9
    buffer_load_dwordx2 v[216:217], v6, s[8:11], s48 offen sc1
    buffer_load_dwordx2 v[218:219], v6, s[8:11], s48 offen offset:256 sc1
    s_lshl_b32 s48, s66, 5
    v_add_u32 v2, s48, v1
    v_lshlrev_b32 v2, 7, v2
    v_add_u32 v2, 0xc11000, v2
    s_mov_b64 exec, 0xffffffff
    global_load_dword v3, v2, s[46:47] sc1
    s_mov_b64 exec, -1
    s_waitcnt vmcnt(13)
    v_mfma_f32_32x32x16_bf16 a[176:191], a[136:139], v[120:123], a[176:191]
    v_mfma_f32_32x32x16_bf16 a[192:207], a[136:139], v[124:127], a[192:207]
    v_mfma_f32_32x32x16_bf16 a[208:223], a[140:143], v[120:123], a[208:223]
    v_mfma_f32_32x32x16_bf16 a[224:239], a[140:143], v[124:127], a[224:239]
    s_waitcnt vmcnt(11)
    v_mfma_f32_32x32x16_bf16 a[176:191], a[144:147], v[128:131], a[176:191]
    v_mfma_f32_32x32x16_bf16 a[192:207], a[144:147], v[132:135], a[192:207]
    v_mfma_f32_32x32x16_bf16 a[208:223], a[148:151], v[128:131], a[208:223]
    v_mfma_f32_32x32x16_bf16 a[224:239], a[148:151], v[132:135], a[224:239]
    s_waitcnt vmcnt(9)
    v_mfma_f32_32x32x16_bf16 a[176:191], a[152:155], v[136:139], a[176:191]
    v_mfma_f32_32x32x16_bf16 a[192:207], a[152:155], v[140:143], a[192:207]
    v_mfma_f32_32x32x16_bf16 a[208:223], a[156:159], v[136:139], a[208:223]
    v_mfma_f32_32x32x16_bf16 a[224:239], a[156:159], v[140:143], a[224:239]
    s_cmp_eq_u32 s3, 3
    s_cbranch_scc1 L_g2_11
    s_waitcnt vmcnt(7)
    v_mfma_f32_32x32x16_bf16 a[176:191], a[160:163], v[144:147], a[176:191]
    v_mfma_f32_32x32x16_bf16 a[192:207], a[160:163], v[148:151], a[192:207]
    v_mfma_f32_32x32x16_bf16 a[208:223], a[164:167], v[144:147], a[208:223]
    v_mfma_f32_32x32x16_bf16 a[224:239], a[164:167], v[148:151], a[224:239]
    s_waitcnt vmcnt(5)
    v_mfma_f32_32x32x16_bf16 a[176:191], a[168:171], v[152:155], a[176:191]
    v_mfma_f32_32x32x16_bf16 a[192:207], a[168:171], v[156:159], a[192:207]
    v_mfma_f32_32x32x16_bf16 a[208:223], a[172:175], v[152:155], a[208:223]
    v_mfma_f32_32x32x16_bf16 a[224:239], a[172:175], v[156:159], a[224:239]
L_g2_11:
    s_waitcnt vmcnt(0)
    s_mov_b64 exec, 0xffffffff
    v_cmp_ne_u32 vcc, s60, v3
    s_mov_b32 s55, 0
    s_cbranch_vccz L_polld_14
L_poll_13:
    s_sleep 1
    global_load_dword v3, v2, s[46:47] sc1
    s_waitcnt vmcnt(0)
    v_cmp_ne_u32 vcc, s60, v3
    s_add_u32 s55, s55, 1
    s_cbranch_vccz L_polld_14
    s_cmp_lt_u32 s55, 200000
    s_cbranch_scc1 L_poll_13
L_polld_14:
    s_mov_b64 exec, -1
    s_add_u32 s8, s46, 0xa00000
    s_addc_u32 s9, s47, 0
    s_mov_b32 s10, 0x200000
    s_mov_b32 s11, 0x20000
    s_mov_b32 s20, s42
    s_mov_b32 s21, s43
    s_mov_b32 s22, 0x200000
    s_mov_b32 s23, 0x20000
    s_lshl_b32 s48, s66, 18
    s_lshl_b32 s49, s65, 8
    s_add_u32 s48, s48, s49
    s_add_u32 s49, s48, 0x20000
    buffer_load_dwordx4 v[220:223], v4, s[8:11], s48 offen sc1
    buffer_load_dwordx4 v[224:227], v4, s[8:11], s49 offen sc1
    s_barrier
    ds_write_b128 v12, a[176:179] offset:0
    ds_write_b128 v12, a[180:183] offset:32
    ds_write_b128 v12, a[184:187] offset:64
    ds_write_b128 v12, a[188:191] offset:96
    ds_write_b128 v12, a[192:195] offset:8704
    ds_write_b128 v12, a[196:199] offset:8736
    ds_write_b128 v12, a[200:203] offset:8768
    ds_write_b128 v12, a[204:207] offset:8800
    ds_write_b128 v12, a[208:211] offset:128
    ds_write_b128 v12, a[212:215] offset:160
    ds_write_b128 v12, a[216:219] offset:192
    ds_write_b128 v12, a[220:223] offset:224
    ds_write_b128 v12, a[224:227] offset:8832
    ds_write_b128 v12, a[228:231] offset:8864
    ds_write_b128 v12, a[232:235] offset:8896
    ds_write_b128 v12, a[236:239] offset:8928
    s_waitcnt vmcnt(0)
    ds_write_b128 v5, v[220:223]
    ds_write_b128 v5, v[224:227] offset:4352
    s_waitcnt lgkmcnt(0)
    s_barrier
    ds_read_b128 v[64:67], v10 offset:0
    ds_read_b128 v[68:71], v10 offset:16
    ds_read_b128 v[72:75], v10 offset:17408
    ds_read_b128 v[76:79], v10 offset:17424
    ds_read_b128 v[80:83], v10 offset:34816
    ds_read_b128 v[84:87], v10 offset:34832
    ds_read_b128 v[88:91], v10 offset:52224
    ds_read_b128 v[92:95], v10 offset:52240
    ds_read_b32 v44, v11 offset:0
    ds_read_b32 v45, v11 offset:272
    ds_read_b32 v46, v11 offset:544
    ds_read_b32 v47, v11 offset:816
    s_mov_b32 s54, 0xbfb8aa3b
    v_mov_b32 v160, v216
    v_mov_b32 v161, v216
    v_mov_b32 v162, v217
    v_mov_b32 v163, v217
    v_lshlrev_b32 v168, 16, v208
    v_and_b32 v169, 0xffff0000, v208
    v_lshlrev_b32 v170, 16, v209
    v_and_b32 v171, 0xffff0000, v209
    v_lshlrev_b32 v172, 16, v210
    v_and_b32 v173, 0xffff0000, v210
    v_lshlrev_b32 v174, 16, v211
    v_and_b32 v175, 0xffff0000, v211
    v_pk_add_f32 v[176:177], v[168:169], v[160:161] neg_lo:[0,1] neg_hi:[0,1]
    v_pk_add_f32 v[178:179], v[170:171], v[160:161] neg_lo:[0,1] neg_hi:[0,1]
    v_pk_add_f32 v[180:181], v[172:173], v[160:161] neg_lo:[0,1] neg_hi:[0,1]
    v_pk_add_f32 v[182:183], v[174:175], v[160:161] neg_lo:[0,1] neg_hi:[0,1]
    v_pk_mul_f32 v[176:177], v[176:177], v[162:163]
    v_pk_mul_f32 v[178:179], v[178:179], v[162:163]
    v_pk_mul_f32 v[180:181], v[180:181], v[162:163]
    v_pk_mul_f32 v[182:183], v[182:183], v[162:163]
    v_mov_b32 v164, v218
    v_mov_b32 v165, v218
    v_mov_b32 v166, v219
    v_mov_b32 v167, v219
    v_lshlrev_b32 v184, 16, v212
    v_and_b32 v185, 0xffff0000, v212
    v_lshlrev_b32 v186, 16, v213
    v_and_b32 v187, 0xffff0000, v213
    v_lshlrev_b32 v188, 16, v214
    v_and_b32 v189, 0xffff0000, v214
    v_lshlrev_b32 v190, 16, v215
    v_and_b32 v191, 0xffff0000, v215
    v_pk_add_f32 v[192:193], v[184:185], v[164:165] neg_lo:[0,1] neg_hi:[0,1]
    v_pk_add_f32 v[194:195], v[186:187], v[164:165] neg_lo:[0,1] neg_hi:[0,1]
    v_pk_add_f32 v[196:197], v[188:189], v[164:165] neg_lo:[0,1] neg_hi:[0,1]
    v_pk_add_f32 v[198:199], v[190:191], v[164:165] neg_lo:[0,1] neg_hi:[0,1]
    v_pk_mul_f32 v[192:193], v[192:193], v[166:167]
    v_pk_mul_f32 v[194:195], v[194:195], v[166:167]
    v_pk_mul_f32 v[196:197], v[196:197], v[166:167]
    v_pk_mul_f32 v[198:199], v[198:199], v[166:167]
    s_waitcnt lgkmcnt(0)
    ds_read_b128 v[96:99], v10 offset:8704
    ds_read_b128 v[100:103], v10 offset:8720
    ds_read_b128 v[104:107], v10 offset:26112
    ds_read_b128 v[108:111], v10 offset:26128
    ds_read_b128 v[112:115], v10 offset:43520
    ds_read_b128 v[116:119], v10 offset:43536
    ds_read_b128 v[120:123], v10 offset:60928
    ds_read_b128 v[124:127], v10 offset:60944
    ds_read_b32 v48, v11 offset:128
    ds_read_b32 v49, v11 offset:400
    ds_read_b32 v50, v11 offset:672
    ds_read_b32 v51, v11 offset:944
    v_pk_add_f32 v[64:65], v[64:65], v[72:73]
    v_pk_add_f32 v[80:81], v[80:81], v[88:89]
    v_pk_add_f32 v[66:67], v[66:67], v[74:75]
    v_pk_add_f32 v[82:83], v[82:83], v[90:91]
    v_pk_add_f32 v[68:69], v[68:69], v[76:77]
    v_pk_add_f32 v[84:85], v[84:85], v[92:93]
    v_pk_add_f32 v[70:71], v[70:71], v[78:79]
    v_pk_add_f32 v[86:87], v[86:87], v[94:95]
    v_pk_add_f32 v[64:65], v[64:65], v[80:81]
    v_pk_add_f32 v[66:67], v[66:67], v[82:83]
    v_pk_add_f32 v[68:69], v[68:69], v[84:85]
    v_pk_add_f32 v[70:71], v[70:71], v[86:87]
    v_pk_mul_f32 v[64:65], v[64:65], v[162:163]
    v_pk_mul_f32 v[66:67], v[66:67], v[162:163]
    v_pk_mul_f32 v[68:69], v[68:69], v[162:163]
    v_pk_mul_f32 v[70:71], v[70:71], v[162:163]
    v_mul_f32 v128, s54, v64
    v_mul_f32 v129, s54, v65
    v_mul_f32 v130, s54, v66
    v_mul_f32 v131, s54, v67
    v_mul_f32 v132, s54, v68
    v_mul_f32 v133, s54, v69
    v_mul_f32 v134, s54, v70
    v_mul_f32 v135, s54, v71
    v_exp_f32 v128, v128
    v_exp_f32 v129, v129
    v_exp_f32 v130, v130
    v_exp_f32 v131, v131
    v_exp_f32 v132, v132
    v_exp_f32 v133, v133
    v_exp_f32 v134, v134
    v_exp_f32 v135, v135
    v_lshlrev_b32 v136, 16, v44
    v_and_b32 v137, 0xffff0000, v44
    v_lshlrev_b32 v138, 16, v45
    v_and_b32 v139, 0xffff0000, v45
    v_lshlrev_b32 v140, 16, v46
    v_and_b32 v141, 0xffff0000, v46
    v_lshlrev_b32 v142, 16, v47
    v_and_b32 v143, 0xffff0000, v47
    v_add_f32 v128, 1.0, v128
    v_add_f32 v129, 1.0, v129
    v_add_f32 v130, 1.0, v130
    v_add_f32 v131, 1.0, v131
    v_add_f32 v132, 1.0, v132
    v_add_f32 v133, 1.0, v133
    v_add_f32 v134, 1.0, v134
    v_add_f32 v135, 1.0, v135
    v_rcp_f32 v128, v128
    v_rcp_f32 v129, v129
    v_rcp_f32 v130, v130
    v_rcp_f32 v131, v131
    v_rcp_f32 v132, v132
    v_rcp_f32 v133, v133
    v_rcp_f32 v134, v134
    v_rcp_f32 v135, v135
    v_pk_mul_f32 v[136:137], v[136:137], v[176:177]
    v_pk_mul_f32 v[138:139], v[138:139], v[178:179]
    v_pk_mul_f32 v[140:141], v[140:141], v[180:181]
    v_pk_mul_f32 v[142:143], v[142:143], v[182:183]
    v_pk_mul_f32 v[136:137], v[136:137], v[64:65]
    v_pk_mul_f32 v[138:139], v[138:139], v[66:67]
    v_pk_mul_f32 v[140:141], v[140:141], v[68:69]
    v_pk_mul_f32 v[142:143], v[142:143], v[70:71]
    v_pk_fma_f32 v[144:145], v[136:137], v[128:129], v[168:169]
    v_pk_fma_f32 v[146:147], v[138:139], v[130:131], v[170:171]
    v_pk_fma_f32 v[148:149], v[140:141], v[132:133], v[172:173]
    v_pk_fma_f32 v[150:151], v[142:143], v[134:135], v[174:175]
    v_cvt_pk_bf16_f32 v152, v144, v145
    v_cvt_pk_bf16_f32 v153, v146, v147
    v_cvt_pk_bf16_f32 v154, v148, v149
    v_cvt_pk_bf16_f32 v155, v150, v151
    buffer_store_dwordx4 v[152:155], v7, s[20:23], s52 offen
    s_waitcnt lgkmcnt(0)
    v_pk_add_f32 v[96:97], v[96:97], v[104:105]
    v_pk_add_f32 v[112:113], v[112:113], v[120:121]
    v_pk_add_f32 v[98:99], v[98:99], v[106:107]
    v_pk_add_f32 v[114:115], v[114:115], v[122:123]
    v_pk_add_f32 v[100:101], v[100:101], v[108:109]
    v_pk_add_f32 v[116:117], v[116:117], v[124:125]
    v_pk_add_f32 v[102:103], v[102:103], v[110:111]
    v_pk_add_f32 v[118:119], v[118:119], v[126:127]
    v_pk_add_f32 v[96:97], v[96:97], v[112:113]
    v_pk_add_f32 v[98:99], v[98:99], v[114:115]
    v_pk_add_f32 v[100:101], v[100:101], v[116:117]
    v_pk_add_f32 v[102:103], v[102:103], v[118:119]
    v_pk_mul_f32 v[96:97], v[96:97], v[166:167]
    v_pk_mul_f32 v[98:99], v[98:99], v[166:167]
    v_pk_mul_f32 v[100:101], v[100:101], v[166:167]
    v_pk_mul_f32 v[102:103], v[102:103], v[166:167]
    v_mul_f32 v128, s54, v96
    v_mul_f32 v129, s54, v97
    v_mul_f32 v130, s54, v98
    v_mul_f32 v131, s54, v99
    v_mul_f32 v132, s54, v100
    v_mul_f32 v133, s54, v101
    v_mul_f32 v134, s54, v102
    v_mul_f32 v135, s54, v103
    v_exp_f32 v128, v128
    v_exp_f32 v129, v129
    v_exp_f32 v130, v130
    v_exp_f32 v131, v131
    v_exp_f32 v132, v132
    v_exp_f32 v133, v133
    v_exp_f32 v134, v134
    v_exp_f32 v135, v135
    v_lshlrev_b32 v136, 16, v48
    v_and_b32 v137, 0xffff0000, v48
    v_lshlrev_b32 v138, 16, v49
    v_and_b32 v139, 0xffff0000, v49
    v_lshlrev_b32 v140, 16, v50
    v_and_b32 v141, 0xffff0000, v50
    v_lshlrev_b32 v142, 16, v51
    v_and_b32 v143, 0xffff0000, v51
    v_add_f32 v128, 1.0, v128
    v_add_f32 v129, 1.0, v129
    v_add_f32 v130, 1.0, v130
    v_add_f32 v131, 1.0, v131
    v_add_f32 v132, 1.0, v132
    v_add_f32 v133, 1.0, v133
    v_add_f32 v134, 1.0, v134
    v_add_f32 v135, 1.0, v135
    v_rcp_f32 v128, v128
    v_rcp_f32 v129, v129
    v_rcp_f32 v130, v130
    v_rcp_f32 v131, v131
    v_rcp_f32 v132, v132
    v_rcp_f32 v133, v133
    v_rcp_f32 v134, v134
    v_rcp_f32 v135, v135
    v_pk_mul_f32 v[136:137], v[136:137], v[192:193]
    v_pk_mul_f32 v[138:139], v[138:139], v[194:195]
    v_pk_mul_f32 v[140:141], v[140:141], v[196:197]
    v_pk_mul_f32 v[142:143], v[142:143], v[198:199]
    v_pk_mul_f32 v[136:137], v[136:137], v[96:97]
    v_pk_mul_f32 v[138:139], v[138:139], v[98:99]
    v_pk_mul_f32 v[140:141], v[140:141], v[100:101]
    v_pk_mul_f32 v[142:143], v[142:143], v[102:103]
    v_pk_fma_f32 v[144:145], v[136:137], v[128:129], v[184:185]
    v_pk_fma_f32 v[146:147], v[138:139], v[130:131], v[186:187]
    v_pk_fma_f32 v[148:149], v[140:141], v[132:133], v[188:189]
    v_pk_fma_f32 v[150:151], v[142:143], v[134:135], v[190:191]
    v_cvt_pk_bf16_f32 v156, v144, v145
    v_cvt_pk_bf16_f32 v157, v146, v147
    v_cvt_pk_bf16_f32 v158, v148, v149
    v_cvt_pk_bf16_f32 v159, v150, v151
    buffer_store_dwordx4 v[156:159], v7, s[20:23], s53 offen
    s_cmp_lg_u32 s2, 0
    s_cbranch_scc1 L_ep_15
    s_cmp_lg_u32 s3, 0
    s_cbranch_scc1 L_ep_15
    s_mov_b32 s54, 0
    s_lshl_b32 s48, s54, 5
    v_mul_u32_u24 v2, 32, v1
    v_add_u32 v2, s48, v2
    v_lshlrev_b32 v2, 7, v2
    v_add_u32 v2, 0xc11000, v2
    s_mov_b64 exec, 0xff
    global_load_dword v3, v2, s[46:47] sc1
    s_waitcnt vmcnt(0)
    s_mov_b64 exec, 0xff
    v_cmp_ne_u32 vcc, s60, v3
    s_mov_b32 s55, 0
    s_cbranch_vccz L_polld_17
L_poll_16:
    s_sleep 1
    global_load_dword v3, v2, s[46:47] sc1
    s_waitcnt vmcnt(0)
    v_cmp_ne_u32 vcc, s60, v3
    s_add_u32 s55, s55, 1
    s_cbranch_vccz L_polld_17
    s_cmp_lt_u32 s55, 200000
    s_cbranch_scc1 L_poll_16
L_polld_17:
    s_mov_b64 exec, -1
    s_add_u32 s48, s61, 1
    v_mov_b32 v3, s48
    v_mov_b32 v2, 0xc00000
    s_mov_b64 exec, 1
    global_store_dword v2, v3, s[46:47] sc0 sc1
L_ep_15:
L_end:
    s_endpgm
.section .rodata,"a"
.p2align 6
.amdhsa_kernel recurrent_scan__ssm_conv_h3__dense_activation_relu__prompt_kernel
  .amdhsa_next_free_vgpr 512
  .amdhsa_next_free_sgpr 102
  .amdhsa_accum_offset 256
  .amdhsa_group_segment_fixed_size 0
  .amdhsa_kernarg_size 96
  .amdhsa_user_sgpr_count 2
  .amdhsa_user_sgpr_kernarg_segment_ptr 1
  .amdhsa_system_sgpr_workgroup_id_x 1
  .amdhsa_float_denorm_mode_32 3
  .amdhsa_float_denorm_mode_16_64 3
.end_amdhsa_kernel
```
